```python
import torch

def _softmax(x, axis=-1):
    return torch.softmax(x, dim=axis)
def _gelu(x):
    return torch.nn.functional.gelu(x, approximate="tanh")
def _silu(x):
    return torch.nn.functional.silu(x)
def _sigmoid(x):
    return torch.sigmoid(x)
def _layernorm(x, axis=-1, eps=1e-5):
    m = x.mean(dim=axis, keepdim=True)
    v = x.var(dim=axis, keepdim=True, unbiased=False)
    return (x - m) / torch.sqrt(v + eps)
def _scatter_add(tgt, idx, src, axis=0):
    return tgt.clone().index_add_(axis, idx, src)
def _segment_sum(src, seg, n):
    out = torch.zeros((n,) + src.shape[1:], dtype=src.dtype)
    return out.index_add_(0, seg, src)
def _pad(x, pw):
    flat = tuple(v for pair in reversed(pw) for v in pair)
    return torch.nn.functional.pad(x, flat)

kernel_name = 'parallel_sum__softmax_full_mha__moe_arch_mod__prompt'

def setup_inputs():

    _w = (lambda a: (lambda t: t.to(torch.bfloat16) if t.is_floating_point() else t)(torch.as_tensor(a)))
    def _A_setup():
        B, S, D = 1, 2048, 512
        return {
            "x": _w((lambda *s: torch.randn(*s, dtype=torch.bfloat16) * 0.05)(B, S, D)),
            "wqkv": _w((lambda *s: torch.randn(*s, dtype=torch.bfloat16) * 0.2)(D, 3 * D)),
            "wo": _w((lambda *s: torch.randn(*s, dtype=torch.bfloat16) * 0.2)(D, D)),
        }
    _A_in = _A_setup()

    def _B_setup():
        B, S, D, F, C = 1, 2048, 512, 1376, 8
        return {
            "x": _w((lambda *s: torch.randn(*s, dtype=torch.bfloat16) * 0.05)(B, S, D)),
            "w_r": _w((lambda *s: torch.randn(*s, dtype=torch.bfloat16) * 1.6)(D)),
            "w_gate": _w((lambda *s: torch.randn(*s, dtype=torch.bfloat16) * 0.2)(D, F)),
            "w_up": _w((lambda *s: torch.randn(*s, dtype=torch.bfloat16) * 0.2)(D, F)),
            "w_down": _w((lambda *s: torch.randn(*s, dtype=torch.bfloat16) * 0.2)(F, D)),
        }
    _B_in = _B_setup()

    return {
        "A_x": _A_in["x"],
        "A_wqkv": _A_in["wqkv"],
        "A_wo": _A_in["wo"],
        "B_x": _B_in["x"],
        "B_w_r": _B_in["w_r"],
        "B_w_gate": _B_in["w_gate"],
        "B_w_up": _B_in["w_up"],
        "B_w_down": _B_in["w_down"],
    }

def reference(A_x, A_wqkv, A_wo, B_x, B_w_r, B_w_gate, B_w_up, B_w_down):
    def _A_ref(x, wqkv, wo):
        B, S, D = x.shape
        H = 32; Dh = D // H
        qkv = (lambda x, *d: x.permute(*d))((x @ wqkv).reshape(B, S, 3, H, Dh), 2, 0, 3, 1, 4)
        q, k, v = qkv[0], qkv[1], qkv[2]
        scale = Dh ** -0.5
        scores = torch.einsum("bhqd,bhkd->bhqk", q, k) * scale
        p = _softmax(scores, axis=-1)
        o = torch.einsum("bhqk,bhkd->bhqd", p, v)
        return (lambda x, *d: x.permute(*d))(o, 0, 2, 1, 3).reshape(B, S, D) @ wo

    def _B_ref(x, w_r, w_gate, w_up, w_down):
        B, S, D = x.shape
        C = 8
        r = x @ w_r
        idx = torch.argsort(-r, axis=-1)[:, :C]
        idx_e = (lambda x, n, axis: torch.repeat_interleave(x, n, dim=axis))(idx.reshape(B, C, 1), D, axis=2)
        x_sel = (lambda x, i, axis: torch.take_along_dim(x, i, dim=axis))(x, idx_e, axis=1)
        g = _silu(x_sel @ w_gate)
        u = x_sel @ w_up
        y = (g * u) @ w_down
        r_sel = _sigmoid((lambda x, i, axis: torch.take_along_dim(x, i, dim=axis))(r, idx, axis=1))
        y = y * r_sel.reshape(B, C, 1)
        b_off = (torch.arange(B) * S).reshape(B, 1)
        flat_idx = (idx + b_off).reshape(B * C)
        zero = (x * 0.0).reshape(B * S, D)
        upd = _scatter_add(zero, flat_idx, y.reshape(B * C, D), axis=0)
        return x + upd.reshape(B, S, D)

    x = A_x
    xn = _layernorm(x, axis=-1)
    return x + _A_ref(xn, A_wqkv, A_wo) + _B_ref(xn, B_w_r, B_w_gate, B_w_up, B_w_down)
```

```asm
; @launch kernel=ln_kernel grid=(512,1,1) block=(256,1,1) lds=0
; @launch kernel=qkv_kernel grid=(299,1,1) block=(256,1,1) lds=75776
; @launch kernel=attn_kernel grid=(528,1,1) block=(256,1,1) lds=0
; @launch kernel=outproj_kernel grid=(256,1,1) block=(256,1,1) lds=98304
.amdgcn_target "amdgcn-amd-amdhsa--gfx950"
.text
.globl ln_kernel
.p2align 8
.type ln_kernel,@function
ln_kernel:
    s_cmp_ge_u32 s2, 512
    s_cbranch_scc1 L_k0_end
    s_load_dwordx2 s[4:5], s[0:1], 0
    s_load_dwordx2 s[6:7], s[0:1], 32
    s_load_dwordx2 s[8:9], s[0:1], 80
    v_lshrrev_b32 v1, 6, v0
    v_and_b32 v2, 63, v0
    s_lshl_b32 s3, s2, 2
    v_add_u32 v3, s3, v1
    v_lshlrev_b32 v1, 10, v3
    v_lshlrev_b32 v2, 4, v2
    v_add_u32 v1, v1, v2
    s_waitcnt lgkmcnt(0)
    s_mov_b32 s12, s4
    s_and_b32 s13, s5, 0xffff
    s_mov_b32 s14, 2097152
    s_mov_b32 s15, 0x00020000
    s_mov_b32 s16, s6
    s_and_b32 s17, s7, 0xffff
    s_mov_b32 s18, 1024
    s_mov_b32 s19, 0x00020000
    s_mov_b32 s20, s8
    s_and_b32 s21, s9, 0xffff
    s_mov_b32 s22, 2097152
    s_mov_b32 s23, 0x00020000
    s_add_u32 s24, s8, 10485760
    s_addc_u32 s25, s9, 0
    s_and_b32 s25, s25, 0xffff
    s_mov_b32 s26, 8192
    s_mov_b32 s27, 0x00020000
    buffer_load_dwordx4 v[4:7], v1, s[12:15], 0 offen
    buffer_load_dwordx4 v[8:11], v2, s[16:19], 0 offen
    s_waitcnt vmcnt(1)
    v_lshlrev_b32 v12, 16, v4
    v_and_b32 v13, 0xffff0000, v4
    v_lshlrev_b32 v14, 16, v5
    v_and_b32 v15, 0xffff0000, v5
    v_lshlrev_b32 v16, 16, v6
    v_and_b32 v17, 0xffff0000, v6
    v_lshlrev_b32 v18, 16, v7
    v_and_b32 v19, 0xffff0000, v7
    v_add_f32 v20, v12, v13
    v_add_f32 v20, v20, v14
    v_add_f32 v20, v20, v15
    v_add_f32 v20, v20, v16
    v_add_f32 v20, v20, v17
    v_add_f32 v20, v20, v18
    v_add_f32 v20, v20, v19
    s_nop 1
    v_add_f32_dpp v20, v20, v20 row_ror:8 row_mask:0xf bank_mask:0xf
    s_nop 1
    v_add_f32_dpp v20, v20, v20 row_ror:4 row_mask:0xf bank_mask:0xf
    s_nop 1
    v_add_f32_dpp v20, v20, v20 row_ror:2 row_mask:0xf bank_mask:0xf
    s_nop 1
    v_add_f32_dpp v20, v20, v20 row_ror:1 row_mask:0xf bank_mask:0xf
    v_mov_b32 v21, v20
    s_nop 1
    v_permlane16_swap_b32 v20, v21
    v_add_f32 v20, v20, v21
    v_mov_b32 v21, v20
    s_nop 1
    v_permlane32_swap_b32 v20, v21
    v_add_f32 v20, v20, v21
    v_mul_f32 v20, 0x3b000000, v20
    v_sub_f32 v22, v12, v20
    v_mul_f32 v23, v22, v22
    v_sub_f32 v22, v13, v20
    v_fmac_f32 v23, v22, v22
    v_sub_f32 v22, v14, v20
    v_fmac_f32 v23, v22, v22
    v_sub_f32 v22, v15, v20
    v_fmac_f32 v23, v22, v22
    v_sub_f32 v22, v16, v20
    v_fmac_f32 v23, v22, v22
    v_sub_f32 v22, v17, v20
    v_fmac_f32 v23, v22, v22
    v_sub_f32 v22, v18, v20
    v_fmac_f32 v23, v22, v22
    v_sub_f32 v22, v19, v20
    v_fmac_f32 v23, v22, v22
    s_nop 1
    v_add_f32_dpp v23, v23, v23 row_ror:8 row_mask:0xf bank_mask:0xf
    s_nop 1
    v_add_f32_dpp v23, v23, v23 row_ror:4 row_mask:0xf bank_mask:0xf
    s_nop 1
    v_add_f32_dpp v23, v23, v23 row_ror:2 row_mask:0xf bank_mask:0xf
    s_nop 1
    v_add_f32_dpp v23, v23, v23 row_ror:1 row_mask:0xf bank_mask:0xf
    v_mov_b32 v21, v23
    s_nop 1
    v_permlane16_swap_b32 v23, v21
    v_add_f32 v23, v23, v21
    v_mov_b32 v21, v23
    s_nop 1
    v_permlane32_swap_b32 v23, v21
    v_add_f32 v23, v23, v21
    v_mul_f32 v23, 0x3b000000, v23
    v_cvt_pk_bf16_f32 v20, 0, v20
    v_cvt_pk_bf16_f32 v23, 0, v23
    v_add_f32 v23, 0x3727c5ac, v23
    v_cvt_pk_bf16_f32 v23, 0, v23
    v_sqrt_f32 v23, v23
    s_nop 0
    v_cvt_pk_bf16_f32 v23, 0, v23
    v_rcp_f32 v23, v23
    s_nop 0
    v_sub_f32 v12, v12, v20
    v_cvt_pk_bf16_f32 v12, 0, v12
    v_mul_f32 v12, v12, v23
    v_cvt_pk_bf16_f32 v12, 0, v12
    v_sub_f32 v13, v13, v20
    v_cvt_pk_bf16_f32 v13, 0, v13
    v_mul_f32 v13, v13, v23
    v_cvt_pk_bf16_f32 v13, 0, v13
    v_sub_f32 v14, v14, v20
    v_cvt_pk_bf16_f32 v14, 0, v14
    v_mul_f32 v14, v14, v23
    v_cvt_pk_bf16_f32 v14, 0, v14
    v_sub_f32 v15, v15, v20
    v_cvt_pk_bf16_f32 v15, 0, v15
    v_mul_f32 v15, v15, v23
    v_cvt_pk_bf16_f32 v15, 0, v15
    v_sub_f32 v16, v16, v20
    v_cvt_pk_bf16_f32 v16, 0, v16
    v_mul_f32 v16, v16, v23
    v_cvt_pk_bf16_f32 v16, 0, v16
    v_sub_f32 v17, v17, v20
    v_cvt_pk_bf16_f32 v17, 0, v17
    v_mul_f32 v17, v17, v23
    v_cvt_pk_bf16_f32 v17, 0, v17
    v_sub_f32 v18, v18, v20
    v_cvt_pk_bf16_f32 v18, 0, v18
    v_mul_f32 v18, v18, v23
    v_cvt_pk_bf16_f32 v18, 0, v18
    v_sub_f32 v19, v19, v20
    v_cvt_pk_bf16_f32 v19, 0, v19
    v_mul_f32 v19, v19, v23
    v_cvt_pk_bf16_f32 v19, 0, v19
    v_cvt_pk_bf16_f32 v4, v12, v13
    v_cvt_pk_bf16_f32 v5, v14, v15
    v_cvt_pk_bf16_f32 v6, v16, v17
    v_cvt_pk_bf16_f32 v7, v18, v19
    buffer_store_dwordx4 v[4:7], v1, s[20:23], 0 offen
    s_waitcnt vmcnt(1)
    v_lshlrev_b32 v24, 16, v8
    v_and_b32 v25, 0xffff0000, v8
    v_lshlrev_b32 v26, 16, v9
    v_and_b32 v27, 0xffff0000, v9
    v_lshlrev_b32 v28, 16, v10
    v_and_b32 v29, 0xffff0000, v10
    v_lshlrev_b32 v30, 16, v11
    v_and_b32 v31, 0xffff0000, v11
    v_mul_f32 v20, v12, v24
    v_fmac_f32 v20, v13, v25
    v_fmac_f32 v20, v14, v26
    v_fmac_f32 v20, v15, v27
    v_fmac_f32 v20, v16, v28
    v_fmac_f32 v20, v17, v29
    v_fmac_f32 v20, v18, v30
    v_fmac_f32 v20, v19, v31
    s_nop 1
    v_add_f32_dpp v20, v20, v20 row_ror:8 row_mask:0xf bank_mask:0xf
    s_nop 1
    v_add_f32_dpp v20, v20, v20 row_ror:4 row_mask:0xf bank_mask:0xf
    s_nop 1
    v_add_f32_dpp v20, v20, v20 row_ror:2 row_mask:0xf bank_mask:0xf
    s_nop 1
    v_add_f32_dpp v20, v20, v20 row_ror:1 row_mask:0xf bank_mask:0xf
    v_mov_b32 v21, v20
    s_nop 1
    v_permlane16_swap_b32 v20, v21
    v_add_f32 v20, v20, v21
    v_mov_b32 v21, v20
    s_nop 1
    v_permlane32_swap_b32 v20, v21
    v_add_f32 v20, v20, v21
    v_cvt_pk_bf16_f32 v20, 0, v20
    v_lshlrev_b32 v3, 2, v3
    s_mov_b64 exec, 1
    buffer_store_dword v20, v3, s[24:27], 0 offen
    s_mov_b64 exec, -1
L_k0_end:
    s_endpgm
.section .rodata,"a"
.p2align 6
.amdhsa_kernel ln_kernel
    .amdhsa_next_free_vgpr 32
    .amdhsa_next_free_sgpr 102
    .amdhsa_accum_offset 32
    .amdhsa_group_segment_fixed_size 0
    .amdhsa_kernarg_size 88
    .amdhsa_user_sgpr_count 2
    .amdhsa_user_sgpr_kernarg_segment_ptr 1
    .amdhsa_system_sgpr_workgroup_id_x 1
.end_amdhsa_kernel
.text
.globl qkv_kernel
.p2align 8
.type qkv_kernel,@function
qkv_kernel:
    s_cmp_ge_u32 s2, 299
    s_cbranch_scc1 L_k1_end
    s_cmp_lt_u32 s2, 43
    s_cbranch_scc1 L_k1_mod
    s_sub_u32 s33, s2, 43
    s_and_b32 s34, s33, 7
    s_lshr_b32 s33, s33, 3
    s_load_dwordx2 s[4:5], s[0:1], 80
    s_load_dwordx2 s[6:7], s[0:1], 8
    v_lshrrev_b32 v1, 6, v0
    s_nop 0
    v_readfirstlane_b32 s35, v1
    v_and_b32 v2, 63, v0
    v_and_b32 v3, 7, v0
    v_lshlrev_b32 v3, 4, v3
    v_lshrrev_b32 v4, 3, v0
    v_and_b32 v4, 31, v4
    v_mul_u32_u24 v5, 3072, v4
    v_add_u32 v5, v5, v3
    v_mul_u32_u24 v6, 448, v4
    v_add_u32 v6, v6, v3
    s_lshl_b32 s36, s33, 16
    v_lshlrev_b32 v7, 10, v4
    v_add_u32 v7, v7, v3
    v_add_u32 v7, s36, v7
    v_mul_u32_u24 v8, 144, v4
    v_add_u32 v8, v8, v3
    v_add_u32 v8, 28672, v8
    s_lshl_b32 s37, s34, 7
    s_add_u32 s24, s37, 0
    s_add_u32 s25, s37, 98304
    s_add_u32 s26, s37, 1024
    s_add_u32 s27, s37, 99328
    s_add_u32 s28, s37, 2048
    s_add_u32 s29, s37, 100352
    s_mov_b32 s30, 0
    s_mov_b32 s31, 32768
    s_and_b32 s38, s35, 1
    s_lshr_b32 s39, s35, 1
    v_and_b32 v9, 31, v2
    v_lshrrev_b32 v10, 5, v2
    s_lshl_b32 s40, s38, 5
    v_add_u32 v11, s40, v9
    v_mul_u32_u24 v11, 144, v11
    v_lshlrev_b32 v12, 4, v10
    v_add_u32 v11, v11, v12
    v_add_u32 v11, 28672, v11
    v_and_b32 v12, 15, v2
    v_lshrrev_b32 v13, 2, v12
    v_and_b32 v12, 3, v12
    v_lshlrev_b32 v14, 3, v10
    v_add_u32 v13, v13, v14
    v_mul_u32_u24 v13, 448, v13
    v_lshrrev_b32 v14, 4, v2
    v_and_b32 v14, 1, v14
    v_lshlrev_b32 v14, 5, v14
    v_lshlrev_b32 v12, 3, v12
    v_add_u32 v13, v13, v14
    v_add_u32 v13, v13, v12
    s_lshl_b32 s40, s39, 6
    v_add_u32 v13, s40, v13
    s_waitcnt lgkmcnt(0)
    s_mov_b32 s12, s6
    s_and_b32 s13, s7, 0xffff
    s_mov_b32 s14, 1572864
    s_mov_b32 s15, 0x00020000
    s_mov_b32 s16, s4
    s_and_b32 s17, s5, 0xffff
    s_mov_b32 s18, 2097152
    s_mov_b32 s19, 0x00020000
    s_add_u32 s20, s4, 2097152
    s_addc_u32 s21, s5, 0
    s_and_b32 s21, s21, 0xffff
    s_mov_b32 s22, 6291456
    s_mov_b32 s23, 0x00020000
    v_mov_b32 v64, 0
    v_mov_b32 v65, 0
    v_mov_b32 v66, 0
    v_mov_b32 v67, 0
    v_mov_b32 v68, 0
    v_mov_b32 v69, 0
    v_mov_b32 v70, 0
    v_mov_b32 v71, 0
    v_mov_b32 v72, 0
    v_mov_b32 v73, 0
    v_mov_b32 v74, 0
    v_mov_b32 v75, 0
    v_mov_b32 v76, 0
    v_mov_b32 v77, 0
    v_mov_b32 v78, 0
    v_mov_b32 v79, 0
    v_mov_b32 v80, 0
    v_mov_b32 v81, 0
    v_mov_b32 v82, 0
    v_mov_b32 v83, 0
    v_mov_b32 v84, 0
    v_mov_b32 v85, 0
    v_mov_b32 v86, 0
    v_mov_b32 v87, 0
    v_mov_b32 v88, 0
    v_mov_b32 v89, 0
    v_mov_b32 v90, 0
    v_mov_b32 v91, 0
    v_mov_b32 v92, 0
    v_mov_b32 v93, 0
    v_mov_b32 v94, 0
    v_mov_b32 v95, 0
    v_mov_b32 v96, 0
    v_mov_b32 v97, 0
    v_mov_b32 v98, 0
    v_mov_b32 v99, 0
    v_mov_b32 v100, 0
    v_mov_b32 v101, 0
    v_mov_b32 v102, 0
    v_mov_b32 v103, 0
    v_mov_b32 v104, 0
    v_mov_b32 v105, 0
    v_mov_b32 v106, 0
    v_mov_b32 v107, 0
    v_mov_b32 v108, 0
    v_mov_b32 v109, 0
    v_mov_b32 v110, 0
    v_mov_b32 v111, 0
    buffer_load_dwordx4 v[128:131], v5, s[12:15], s24 offen
    buffer_load_dwordx4 v[132:135], v5, s[12:15], s25 offen
    buffer_load_dwordx4 v[136:139], v5, s[12:15], s26 offen
    buffer_load_dwordx4 v[140:143], v5, s[12:15], s27 offen
    buffer_load_dwordx4 v[144:147], v5, s[12:15], s28 offen
    buffer_load_dwordx4 v[148:151], v5, s[12:15], s29 offen
    buffer_load_dwordx4 v[152:155], v7, s[16:19], s30 offen
    buffer_load_dwordx4 v[156:159], v7, s[16:19], s31 offen
    s_add_u32 s24, s24, 196608
    s_add_u32 s25, s25, 196608
    s_add_u32 s26, s26, 196608
    s_add_u32 s27, s27, 196608
    s_add_u32 s28, s28, 196608
    s_add_u32 s29, s29, 196608
    s_add_u32 s30, s30, 128
    s_add_u32 s31, s31, 128
    buffer_load_dwordx4 v[160:163], v5, s[12:15], s24 offen
    buffer_load_dwordx4 v[164:167], v5, s[12:15], s25 offen
    buffer_load_dwordx4 v[168:171], v5, s[12:15], s26 offen
    buffer_load_dwordx4 v[172:175], v5, s[12:15], s27 offen
    buffer_load_dwordx4 v[176:179], v5, s[12:15], s28 offen
    buffer_load_dwordx4 v[180:183], v5, s[12:15], s29 offen
    buffer_load_dwordx4 v[184:187], v7, s[16:19], s30 offen
    buffer_load_dwordx4 v[188:191], v7, s[16:19], s31 offen
    s_add_u32 s24, s24, 196608
    s_add_u32 s25, s25, 196608
    s_add_u32 s26, s26, 196608
    s_add_u32 s27, s27, 196608
    s_add_u32 s28, s28, 196608
    s_add_u32 s29, s29, 196608
    s_add_u32 s30, s30, 128
    s_add_u32 s31, s31, 128
    buffer_load_dwordx4 v[192:195], v5, s[12:15], s24 offen
    buffer_load_dwordx4 v[196:199], v5, s[12:15], s25 offen
    buffer_load_dwordx4 v[200:203], v5, s[12:15], s26 offen
    buffer_load_dwordx4 v[204:207], v5, s[12:15], s27 offen
    buffer_load_dwordx4 v[208:211], v5, s[12:15], s28 offen
    buffer_load_dwordx4 v[212:215], v5, s[12:15], s29 offen
    buffer_load_dwordx4 v[216:219], v7, s[16:19], s30 offen
    buffer_load_dwordx4 v[220:223], v7, s[16:19], s31 offen
    s_add_u32 s24, s24, 196608
    s_add_u32 s25, s25, 196608
    s_add_u32 s26, s26, 196608
    s_add_u32 s27, s27, 196608
    s_add_u32 s28, s28, 196608
    s_add_u32 s29, s29, 196608
    s_add_u32 s30, s30, 128
    s_add_u32 s31, s31, 128
    buffer_load_dwordx4 v[224:227], v5, s[12:15], s24 offen
    buffer_load_dwordx4 v[228:231], v5, s[12:15], s25 offen
    buffer_load_dwordx4 v[232:235], v5, s[12:15], s26 offen
    buffer_load_dwordx4 v[236:239], v5, s[12:15], s27 offen
    buffer_load_dwordx4 v[240:243], v5, s[12:15], s28 offen
    buffer_load_dwordx4 v[244:247], v5, s[12:15], s29 offen
    buffer_load_dwordx4 v[248:251], v7, s[16:19], s30 offen
    buffer_load_dwordx4 v[252:255], v7, s[16:19], s31 offen
    s_add_u32 s24, s24, 196608
    s_add_u32 s25, s25, 196608
    s_add_u32 s26, s26, 196608
    s_add_u32 s27, s27, 196608
    s_add_u32 s28, s28, 196608
    s_add_u32 s29, s29, 196608
    s_add_u32 s30, s30, 128
    s_add_u32 s31, s31, 128
    s_waitcnt vmcnt(24)
    ds_write_b128 v6, v[128:131] offset:0
    ds_write_b128 v6, v[132:135] offset:14336
    ds_write_b128 v6, v[136:139] offset:128
    ds_write_b128 v6, v[140:143] offset:14464
    ds_write_b128 v6, v[144:147] offset:256
    ds_write_b128 v6, v[148:151] offset:14592
    ds_write_b128 v8, v[152:155] offset:0
    ds_write_b128 v8, v[156:159] offset:4608
    s_waitcnt lgkmcnt(0)
    buffer_load_dwordx4 v[128:131], v5, s[12:15], s24 offen
    buffer_load_dwordx4 v[132:135], v5, s[12:15], s25 offen
    buffer_load_dwordx4 v[136:139], v5, s[12:15], s26 offen
    buffer_load_dwordx4 v[140:143], v5, s[12:15], s27 offen
    buffer_load_dwordx4 v[144:147], v5, s[12:15], s28 offen
    buffer_load_dwordx4 v[148:151], v5, s[12:15], s29 offen
    buffer_load_dwordx4 v[152:155], v7, s[16:19], s30 offen
    buffer_load_dwordx4 v[156:159], v7, s[16:19], s31 offen
    s_add_u32 s24, s24, 196608
    s_add_u32 s25, s25, 196608
    s_add_u32 s26, s26, 196608
    s_add_u32 s27, s27, 196608
    s_add_u32 s28, s28, 196608
    s_add_u32 s29, s29, 196608
    s_add_u32 s30, s30, 128
    s_add_u32 s31, s31, 128
    s_barrier
    ds_read_b128 v[16:19], v11 offset:0
    ds_read_b64_tr_b16 v[20:21], v13 offset:0
    ds_read_b64_tr_b16 v[22:23], v13 offset:1792
    ds_read_b64_tr_b16 v[24:25], v13 offset:128
    ds_read_b64_tr_b16 v[26:27], v13 offset:1920
    ds_read_b64_tr_b16 v[28:29], v13 offset:256
    ds_read_b64_tr_b16 v[30:31], v13 offset:2048
    ds_read_b128 v[112:115], v11 offset:32
    ds_read_b64_tr_b16 v[116:117], v13 offset:7168
    ds_read_b64_tr_b16 v[118:119], v13 offset:8960
    ds_read_b64_tr_b16 v[120:121], v13 offset:7296
    ds_read_b64_tr_b16 v[122:123], v13 offset:9088
    ds_read_b64_tr_b16 v[124:125], v13 offset:7424
    ds_read_b64_tr_b16 v[126:127], v13 offset:9216
    s_waitcnt lgkmcnt(7)
    v_mfma_f32_32x32x16_bf16 v[64:79], v[20:23], v[16:19], v[64:79]
    v_mfma_f32_32x32x16_bf16 v[80:95], v[24:27], v[16:19], v[80:95]
    v_mfma_f32_32x32x16_bf16 v[96:111], v[16:19], v[28:31], v[96:111]
    ds_read_b128 v[16:19], v11 offset:64
    ds_read_b64_tr_b16 v[20:21], v13 offset:14336
    ds_read_b64_tr_b16 v[22:23], v13 offset:16128
    ds_read_b64_tr_b16 v[24:25], v13 offset:14464
    ds_read_b64_tr_b16 v[26:27], v13 offset:16256
    ds_read_b64_tr_b16 v[28:29], v13 offset:14592
    ds_read_b64_tr_b16 v[30:31], v13 offset:16384
    s_waitcnt lgkmcnt(7)
    v_mfma_f32_32x32x16_bf16 v[64:79], v[116:119], v[112:115], v[64:79]
    v_mfma_f32_32x32x16_bf16 v[80:95], v[120:123], v[112:115], v[80:95]
    v_mfma_f32_32x32x16_bf16 v[96:111], v[112:115], v[124:127], v[96:111]
    ds_read_b128 v[112:115], v11 offset:96
    ds_read_b64_tr_b16 v[116:117], v13 offset:21504
    ds_read_b64_tr_b16 v[118:119], v13 offset:23296
    ds_read_b64_tr_b16 v[120:121], v13 offset:21632
    ds_read_b64_tr_b16 v[122:123], v13 offset:23424
    ds_read_b64_tr_b16 v[124:125], v13 offset:21760
    ds_read_b64_tr_b16 v[126:127], v13 offset:23552
    s_waitcnt lgkmcnt(7)
    v_mfma_f32_32x32x16_bf16 v[64:79], v[20:23], v[16:19], v[64:79]
    v_mfma_f32_32x32x16_bf16 v[80:95], v[24:27], v[16:19], v[80:95]
    v_mfma_f32_32x32x16_bf16 v[96:111], v[16:19], v[28:31], v[96:111]
    s_waitcnt lgkmcnt(0)
    v_mfma_f32_32x32x16_bf16 v[64:79], v[116:119], v[112:115], v[64:79]
    v_mfma_f32_32x32x16_bf16 v[80:95], v[120:123], v[112:115], v[80:95]
    v_mfma_f32_32x32x16_bf16 v[96:111], v[112:115], v[124:127], v[96:111]
    s_waitcnt vmcnt(24)
    ds_write_b128 v6, v[160:163] offset:37888
    ds_write_b128 v6, v[164:167] offset:52224
    ds_write_b128 v6, v[168:171] offset:38016
    ds_write_b128 v6, v[172:175] offset:52352
    ds_write_b128 v6, v[176:179] offset:38144
    ds_write_b128 v6, v[180:183] offset:52480
    ds_write_b128 v8, v[184:187] offset:37888
    ds_write_b128 v8, v[188:191] offset:42496
    s_waitcnt lgkmcnt(0)
    buffer_load_dwordx4 v[160:163], v5, s[12:15], s24 offen
    buffer_load_dwordx4 v[164:167], v5, s[12:15], s25 offen
    buffer_load_dwordx4 v[168:171], v5, s[12:15], s26 offen
    buffer_load_dwordx4 v[172:175], v5, s[12:15], s27 offen
    buffer_load_dwordx4 v[176:179], v5, s[12:15], s28 offen
    buffer_load_dwordx4 v[180:183], v5, s[12:15], s29 offen
    buffer_load_dwordx4 v[184:187], v7, s[16:19], s30 offen
    buffer_load_dwordx4 v[188:191], v7, s[16:19], s31 offen
    s_add_u32 s24, s24, 196608
    s_add_u32 s25, s25, 196608
    s_add_u32 s26, s26, 196608
    s_add_u32 s27, s27, 196608
    s_add_u32 s28, s28, 196608
    s_add_u32 s29, s29, 196608
    s_add_u32 s30, s30, 128
    s_add_u32 s31, s31, 128
    s_barrier
    ds_read_b128 v[16:19], v11 offset:37888
    ds_read_b64_tr_b16 v[20:21], v13 offset:37888
    ds_read_b64_tr_b16 v[22:23], v13 offset:39680
    ds_read_b64_tr_b16 v[24:25], v13 offset:38016
    ds_read_b64_tr_b16 v[26:27], v13 offset:39808
    ds_read_b64_tr_b16 v[28:29], v13 offset:38144
    ds_read_b64_tr_b16 v[30:31], v13 offset:39936
    ds_read_b128 v[112:115], v11 offset:37920
    ds_read_b64_tr_b16 v[116:117], v13 offset:45056
    ds_read_b64_tr_b16 v[118:119], v13 offset:46848
    ds_read_b64_tr_b16 v[120:121], v13 offset:45184
    ds_read_b64_tr_b16 v[122:123], v13 offset:46976
    ds_read_b64_tr_b16 v[124:125], v13 offset:45312
    ds_read_b64_tr_b16 v[126:127], v13 offset:47104
    s_waitcnt lgkmcnt(7)
    v_mfma_f32_32x32x16_bf16 v[64:79], v[20:23], v[16:19], v[64:79]
    v_mfma_f32_32x32x16_bf16 v[80:95], v[24:27], v[16:19], v[80:95]
    v_mfma_f32_32x32x16_bf16 v[96:111], v[16:19], v[28:31], v[96:111]
    ds_read_b128 v[16:19], v11 offset:37952
    ds_read_b64_tr_b16 v[20:21], v13 offset:52224
    ds_read_b64_tr_b16 v[22:23], v13 offset:54016
    ds_read_b64_tr_b16 v[24:25], v13 offset:52352
    ds_read_b64_tr_b16 v[26:27], v13 offset:54144
    ds_read_b64_tr_b16 v[28:29], v13 offset:52480
    ds_read_b64_tr_b16 v[30:31], v13 offset:54272
    s_waitcnt lgkmcnt(7)
    v_mfma_f32_32x32x16_bf16 v[64:79], v[116:119], v[112:115], v[64:79]
    v_mfma_f32_32x32x16_bf16 v[80:95], v[120:123], v[112:115], v[80:95]
    v_mfma_f32_32x32x16_bf16 v[96:111], v[112:115], v[124:127], v[96:111]
    ds_read_b128 v[112:115], v11 offset:37984
    ds_read_b64_tr_b16 v[116:117], v13 offset:59392
    ds_read_b64_tr_b16 v[118:119], v13 offset:61184
    ds_read_b64_tr_b16 v[120:121], v13 offset:59520
    ds_read_b64_tr_b16 v[122:123], v13 offset:61312
    ds_read_b64_tr_b16 v[124:125], v13 offset:59648
    ds_read_b64_tr_b16 v[126:127], v13 offset:61440
    s_waitcnt lgkmcnt(7)
    v_mfma_f32_32x32x16_bf16 v[64:79], v[20:23], v[16:19], v[64:79]
    v_mfma_f32_32x32x16_bf16 v[80:95], v[24:27], v[16:19], v[80:95]
    v_mfma_f32_32x32x16_bf16 v[96:111], v[16:19], v[28:31], v[96:111]
    s_waitcnt lgkmcnt(0)
    v_mfma_f32_32x32x16_bf16 v[64:79], v[116:119], v[112:115], v[64:79]
    v_mfma_f32_32x32x16_bf16 v[80:95], v[120:123], v[112:115], v[80:95]
    v_mfma_f32_32x32x16_bf16 v[96:111], v[112:115], v[124:127], v[96:111]
    s_waitcnt vmcnt(24)
    ds_write_b128 v6, v[192:195] offset:0
    ds_write_b128 v6, v[196:199] offset:14336
    ds_write_b128 v6, v[200:203] offset:128
    ds_write_b128 v6, v[204:207] offset:14464
    ds_write_b128 v6, v[208:211] offset:256
    ds_write_b128 v6, v[212:215] offset:14592
    ds_write_b128 v8, v[216:219] offset:0
    ds_write_b128 v8, v[220:223] offset:4608
    s_waitcnt lgkmcnt(0)
    buffer_load_dwordx4 v[192:195], v5, s[12:15], s24 offen
    buffer_load_dwordx4 v[196:199], v5, s[12:15], s25 offen
    buffer_load_dwordx4 v[200:203], v5, s[12:15], s26 offen
    buffer_load_dwordx4 v[204:207], v5, s[12:15], s27 offen
    buffer_load_dwordx4 v[208:211], v5, s[12:15], s28 offen
    buffer_load_dwordx4 v[212:215], v5, s[12:15], s29 offen
    buffer_load_dwordx4 v[216:219], v7, s[16:19], s30 offen
    buffer_load_dwordx4 v[220:223], v7, s[16:19], s31 offen
    s_add_u32 s24, s24, 196608
    s_add_u32 s25, s25, 196608
    s_add_u32 s26, s26, 196608
    s_add_u32 s27, s27, 196608
    s_add_u32 s28, s28, 196608
    s_add_u32 s29, s29, 196608
    s_add_u32 s30, s30, 128
    s_add_u32 s31, s31, 128
    s_barrier
    ds_read_b128 v[16:19], v11 offset:0
    ds_read_b64_tr_b16 v[20:21], v13 offset:0
    ds_read_b64_tr_b16 v[22:23], v13 offset:1792
    ds_read_b64_tr_b16 v[24:25], v13 offset:128
    ds_read_b64_tr_b16 v[26:27], v13 offset:1920
    ds_read_b64_tr_b16 v[28:29], v13 offset:256
    ds_read_b64_tr_b16 v[30:31], v13 offset:2048
    ds_read_b128 v[112:115], v11 offset:32
    ds_read_b64_tr_b16 v[116:117], v13 offset:7168
    ds_read_b64_tr_b16 v[118:119], v13 offset:8960
    ds_read_b64_tr_b16 v[120:121], v13 offset:7296
    ds_read_b64_tr_b16 v[122:123], v13 offset:9088
    ds_read_b64_tr_b16 v[124:125], v13 offset:7424
    ds_read_b64_tr_b16 v[126:127], v13 offset:9216
    s_waitcnt lgkmcnt(7)
    v_mfma_f32_32x32x16_bf16 v[64:79], v[20:23], v[16:19], v[64:79]
    v_mfma_f32_32x32x16_bf16 v[80:95], v[24:27], v[16:19], v[80:95]
    v_mfma_f32_32x32x16_bf16 v[96:111], v[16:19], v[28:31], v[96:111]
    ds_read_b128 v[16:19], v11 offset:64
    ds_read_b64_tr_b16 v[20:21], v13 offset:14336
    ds_read_b64_tr_b16 v[22:23], v13 offset:16128
    ds_read_b64_tr_b16 v[24:25], v13 offset:14464
    ds_read_b64_tr_b16 v[26:27], v13 offset:16256
    ds_read_b64_tr_b16 v[28:29], v13 offset:14592
    ds_read_b64_tr_b16 v[30:31], v13 offset:16384
    s_waitcnt lgkmcnt(7)
    v_mfma_f32_32x32x16_bf16 v[64:79], v[116:119], v[112:115], v[64:79]
    v_mfma_f32_32x32x16_bf16 v[80:95], v[120:123], v[112:115], v[80:95]
    v_mfma_f32_32x32x16_bf16 v[96:111], v[112:115], v[124:127], v[96:111]
    ds_read_b128 v[112:115], v11 offset:96
    ds_read_b64_tr_b16 v[116:117], v13 offset:21504
    ds_read_b64_tr_b16 v[118:119], v13 offset:23296
    ds_read_b64_tr_b16 v[120:121], v13 offset:21632
    ds_read_b64_tr_b16 v[122:123], v13 offset:23424
    ds_read_b64_tr_b16 v[124:125], v13 offset:21760
    ds_read_b64_tr_b16 v[126:127], v13 offset:23552
    s_waitcnt lgkmcnt(7)
    v_mfma_f32_32x32x16_bf16 v[64:79], v[20:23], v[16:19], v[64:79]
    v_mfma_f32_32x32x16_bf16 v[80:95], v[24:27], v[16:19], v[80:95]
    v_mfma_f32_32x32x16_bf16 v[96:111], v[16:19], v[28:31], v[96:111]
    s_waitcnt lgkmcnt(0)
    v_mfma_f32_32x32x16_bf16 v[64:79], v[116:119], v[112:115], v[64:79]
    v_mfma_f32_32x32x16_bf16 v[80:95], v[120:123], v[112:115], v[80:95]
    v_mfma_f32_32x32x16_bf16 v[96:111], v[112:115], v[124:127], v[96:111]
    s_waitcnt vmcnt(24)
    ds_write_b128 v6, v[224:227] offset:37888
    ds_write_b128 v6, v[228:231] offset:52224
    ds_write_b128 v6, v[232:235] offset:38016
    ds_write_b128 v6, v[236:239] offset:52352
    ds_write_b128 v6, v[240:243] offset:38144
    ds_write_b128 v6, v[244:247] offset:52480
    ds_write_b128 v8, v[248:251] offset:37888
    ds_write_b128 v8, v[252:255] offset:42496
    s_waitcnt lgkmcnt(0)
    buffer_load_dwordx4 v[224:227], v5, s[12:15], s24 offen
    buffer_load_dwordx4 v[228:231], v5, s[12:15], s25 offen
    buffer_load_dwordx4 v[232:235], v5, s[12:15], s26 offen
    buffer_load_dwordx4 v[236:239], v5, s[12:15], s27 offen
    buffer_load_dwordx4 v[240:243], v5, s[12:15], s28 offen
    buffer_load_dwordx4 v[244:247], v5, s[12:15], s29 offen
    buffer_load_dwordx4 v[248:251], v7, s[16:19], s30 offen
    buffer_load_dwordx4 v[252:255], v7, s[16:19], s31 offen
    s_add_u32 s24, s24, 196608
    s_add_u32 s25, s25, 196608
    s_add_u32 s26, s26, 196608
    s_add_u32 s27, s27, 196608
    s_add_u32 s28, s28, 196608
    s_add_u32 s29, s29, 196608
    s_add_u32 s30, s30, 128
    s_add_u32 s31, s31, 128
    s_barrier
    ds_read_b128 v[16:19], v11 offset:37888
    ds_read_b64_tr_b16 v[20:21], v13 offset:37888
    ds_read_b64_tr_b16 v[22:23], v13 offset:39680
    ds_read_b64_tr_b16 v[24:25], v13 offset:38016
    ds_read_b64_tr_b16 v[26:27], v13 offset:39808
    ds_read_b64_tr_b16 v[28:29], v13 offset:38144
    ds_read_b64_tr_b16 v[30:31], v13 offset:39936
    ds_read_b128 v[112:115], v11 offset:37920
    ds_read_b64_tr_b16 v[116:117], v13 offset:45056
    ds_read_b64_tr_b16 v[118:119], v13 offset:46848
    ds_read_b64_tr_b16 v[120:121], v13 offset:45184
    ds_read_b64_tr_b16 v[122:123], v13 offset:46976
    ds_read_b64_tr_b16 v[124:125], v13 offset:45312
    ds_read_b64_tr_b16 v[126:127], v13 offset:47104
    s_waitcnt lgkmcnt(7)
    v_mfma_f32_32x32x16_bf16 v[64:79], v[20:23], v[16:19], v[64:79]
    v_mfma_f32_32x32x16_bf16 v[80:95], v[24:27], v[16:19], v[80:95]
    v_mfma_f32_32x32x16_bf16 v[96:111], v[16:19], v[28:31], v[96:111]
    ds_read_b128 v[16:19], v11 offset:37952
    ds_read_b64_tr_b16 v[20:21], v13 offset:52224
    ds_read_b64_tr_b16 v[22:23], v13 offset:54016
    ds_read_b64_tr_b16 v[24:25], v13 offset:52352
    ds_read_b64_tr_b16 v[26:27], v13 offset:54144
    ds_read_b64_tr_b16 v[28:29], v13 offset:52480
    ds_read_b64_tr_b16 v[30:31], v13 offset:54272
    s_waitcnt lgkmcnt(7)
    v_mfma_f32_32x32x16_bf16 v[64:79], v[116:119], v[112:115], v[64:79]
    v_mfma_f32_32x32x16_bf16 v[80:95], v[120:123], v[112:115], v[80:95]
    v_mfma_f32_32x32x16_bf16 v[96:111], v[112:115], v[124:127], v[96:111]
    ds_read_b128 v[112:115], v11 offset:37984
    ds_read_b64_tr_b16 v[116:117], v13 offset:59392
    ds_read_b64_tr_b16 v[118:119], v13 offset:61184
    ds_read_b64_tr_b16 v[120:121], v13 offset:59520
    ds_read_b64_tr_b16 v[122:123], v13 offset:61312
    ds_read_b64_tr_b16 v[124:125], v13 offset:59648
    ds_read_b64_tr_b16 v[126:127], v13 offset:61440
    s_waitcnt lgkmcnt(7)
    v_mfma_f32_32x32x16_bf16 v[64:79], v[20:23], v[16:19], v[64:79]
    v_mfma_f32_32x32x16_bf16 v[80:95], v[24:27], v[16:19], v[80:95]
    v_mfma_f32_32x32x16_bf16 v[96:111], v[16:19], v[28:31], v[96:111]
    s_waitcnt lgkmcnt(0)
    v_mfma_f32_32x32x16_bf16 v[64:79], v[116:119], v[112:115], v[64:79]
    v_mfma_f32_32x32x16_bf16 v[80:95], v[120:123], v[112:115], v[80:95]
    v_mfma_f32_32x32x16_bf16 v[96:111], v[112:115], v[124:127], v[96:111]
    s_waitcnt vmcnt(24)
    ds_write_b128 v6, v[128:131] offset:0
    ds_write_b128 v6, v[132:135] offset:14336
    ds_write_b128 v6, v[136:139] offset:128
    ds_write_b128 v6, v[140:143] offset:14464
    ds_write_b128 v6, v[144:147] offset:256
    ds_write_b128 v6, v[148:151] offset:14592
    ds_write_b128 v8, v[152:155] offset:0
    ds_write_b128 v8, v[156:159] offset:4608
    s_waitcnt lgkmcnt(0)
    s_barrier
    ds_read_b128 v[16:19], v11 offset:0
    ds_read_b64_tr_b16 v[20:21], v13 offset:0
    ds_read_b64_tr_b16 v[22:23], v13 offset:1792
    ds_read_b64_tr_b16 v[24:25], v13 offset:128
    ds_read_b64_tr_b16 v[26:27], v13 offset:1920
    ds_read_b64_tr_b16 v[28:29], v13 offset:256
    ds_read_b64_tr_b16 v[30:31], v13 offset:2048
    ds_read_b128 v[112:115], v11 offset:32
    ds_read_b64_tr_b16 v[116:117], v13 offset:7168
    ds_read_b64_tr_b16 v[118:119], v13 offset:8960
    ds_read_b64_tr_b16 v[120:121], v13 offset:7296
    ds_read_b64_tr_b16 v[122:123], v13 offset:9088
    ds_read_b64_tr_b16 v[124:125], v13 offset:7424
    ds_read_b64_tr_b16 v[126:127], v13 offset:9216
    s_waitcnt lgkmcnt(7)
    v_mfma_f32_32x32x16_bf16 v[64:79], v[20:23], v[16:19], v[64:79]
    v_mfma_f32_32x32x16_bf16 v[80:95], v[24:27], v[16:19], v[80:95]
    v_mfma_f32_32x32x16_bf16 v[96:111], v[16:19], v[28:31], v[96:111]
    ds_read_b128 v[16:19], v11 offset:64
    ds_read_b64_tr_b16 v[20:21], v13 offset:14336
    ds_read_b64_tr_b16 v[22:23], v13 offset:16128
    ds_read_b64_tr_b16 v[24:25], v13 offset:14464
    ds_read_b64_tr_b16 v[26:27], v13 offset:16256
    ds_read_b64_tr_b16 v[28:29], v13 offset:14592
    ds_read_b64_tr_b16 v[30:31], v13 offset:16384
    s_waitcnt lgkmcnt(7)
    v_mfma_f32_32x32x16_bf16 v[64:79], v[116:119], v[112:115], v[64:79]
    v_mfma_f32_32x32x16_bf16 v[80:95], v[120:123], v[112:115], v[80:95]
    v_mfma_f32_32x32x16_bf16 v[96:111], v[112:115], v[124:127], v[96:111]
    ds_read_b128 v[112:115], v11 offset:96
    ds_read_b64_tr_b16 v[116:117], v13 offset:21504
    ds_read_b64_tr_b16 v[118:119], v13 offset:23296
    ds_read_b64_tr_b16 v[120:121], v13 offset:21632
    ds_read_b64_tr_b16 v[122:123], v13 offset:23424
    ds_read_b64_tr_b16 v[124:125], v13 offset:21760
    ds_read_b64_tr_b16 v[126:127], v13 offset:23552
    s_waitcnt lgkmcnt(7)
    v_mfma_f32_32x32x16_bf16 v[64:79], v[20:23], v[16:19], v[64:79]
    v_mfma_f32_32x32x16_bf16 v[80:95], v[24:27], v[16:19], v[80:95]
    v_mfma_f32_32x32x16_bf16 v[96:111], v[16:19], v[28:31], v[96:111]
    s_waitcnt lgkmcnt(0)
    v_mfma_f32_32x32x16_bf16 v[64:79], v[116:119], v[112:115], v[64:79]
    v_mfma_f32_32x32x16_bf16 v[80:95], v[120:123], v[112:115], v[80:95]
    v_mfma_f32_32x32x16_bf16 v[96:111], v[112:115], v[124:127], v[96:111]
    s_waitcnt vmcnt(16)
    ds_write_b128 v6, v[160:163] offset:37888
    ds_write_b128 v6, v[164:167] offset:52224
    ds_write_b128 v6, v[168:171] offset:38016
    ds_write_b128 v6, v[172:175] offset:52352
    ds_write_b128 v6, v[176:179] offset:38144
    ds_write_b128 v6, v[180:183] offset:52480
    ds_write_b128 v8, v[184:187] offset:37888
    ds_write_b128 v8, v[188:191] offset:42496
    s_waitcnt lgkmcnt(0)
    s_barrier
    ds_read_b128 v[16:19], v11 offset:37888
    ds_read_b64_tr_b16 v[20:21], v13 offset:37888
    ds_read_b64_tr_b16 v[22:23], v13 offset:39680
    ds_read_b64_tr_b16 v[24:25], v13 offset:38016
    ds_read_b64_tr_b16 v[26:27], v13 offset:39808
    ds_read_b64_tr_b16 v[28:29], v13 offset:38144
    ds_read_b64_tr_b16 v[30:31], v13 offset:39936
    ds_read_b128 v[112:115], v11 offset:37920
    ds_read_b64_tr_b16 v[116:117], v13 offset:45056
    ds_read_b64_tr_b16 v[118:119], v13 offset:46848
    ds_read_b64_tr_b16 v[120:121], v13 offset:45184
    ds_read_b64_tr_b16 v[122:123], v13 offset:46976
    ds_read_b64_tr_b16 v[124:125], v13 offset:45312
    ds_read_b64_tr_b16 v[126:127], v13 offset:47104
    s_waitcnt lgkmcnt(7)
    v_mfma_f32_32x32x16_bf16 v[64:79], v[20:23], v[16:19], v[64:79]
    v_mfma_f32_32x32x16_bf16 v[80:95], v[24:27], v[16:19], v[80:95]
    v_mfma_f32_32x32x16_bf16 v[96:111], v[16:19], v[28:31], v[96:111]
    ds_read_b128 v[16:19], v11 offset:37952
    ds_read_b64_tr_b16 v[20:21], v13 offset:52224
    ds_read_b64_tr_b16 v[22:23], v13 offset:54016
    ds_read_b64_tr_b16 v[24:25], v13 offset:52352
    ds_read_b64_tr_b16 v[26:27], v13 offset:54144
    ds_read_b64_tr_b16 v[28:29], v13 offset:52480
    ds_read_b64_tr_b16 v[30:31], v13 offset:54272
    s_waitcnt lgkmcnt(7)
    v_mfma_f32_32x32x16_bf16 v[64:79], v[116:119], v[112:115], v[64:79]
    v_mfma_f32_32x32x16_bf16 v[80:95], v[120:123], v[112:115], v[80:95]
    v_mfma_f32_32x32x16_bf16 v[96:111], v[112:115], v[124:127], v[96:111]
    ds_read_b128 v[112:115], v11 offset:37984
    ds_read_b64_tr_b16 v[116:117], v13 offset:59392
    ds_read_b64_tr_b16 v[118:119], v13 offset:61184
    ds_read_b64_tr_b16 v[120:121], v13 offset:59520
    ds_read_b64_tr_b16 v[122:123], v13 offset:61312
    ds_read_b64_tr_b16 v[124:125], v13 offset:59648
    ds_read_b64_tr_b16 v[126:127], v13 offset:61440
    s_waitcnt lgkmcnt(7)
    v_mfma_f32_32x32x16_bf16 v[64:79], v[20:23], v[16:19], v[64:79]
    v_mfma_f32_32x32x16_bf16 v[80:95], v[24:27], v[16:19], v[80:95]
    v_mfma_f32_32x32x16_bf16 v[96:111], v[16:19], v[28:31], v[96:111]
    s_waitcnt lgkmcnt(0)
    v_mfma_f32_32x32x16_bf16 v[64:79], v[116:119], v[112:115], v[64:79]
    v_mfma_f32_32x32x16_bf16 v[80:95], v[120:123], v[112:115], v[80:95]
    v_mfma_f32_32x32x16_bf16 v[96:111], v[112:115], v[124:127], v[96:111]
    s_waitcnt vmcnt(8)
    ds_write_b128 v6, v[192:195] offset:0
    ds_write_b128 v6, v[196:199] offset:14336
    ds_write_b128 v6, v[200:203] offset:128
    ds_write_b128 v6, v[204:207] offset:14464
    ds_write_b128 v6, v[208:211] offset:256
    ds_write_b128 v6, v[212:215] offset:14592
    ds_write_b128 v8, v[216:219] offset:0
    ds_write_b128 v8, v[220:223] offset:4608
    s_waitcnt lgkmcnt(0)
    s_barrier
    ds_read_b128 v[16:19], v11 offset:0
    ds_read_b64_tr_b16 v[20:21], v13 offset:0
    ds_read_b64_tr_b16 v[22:23], v13 offset:1792
    ds_read_b64_tr_b16 v[24:25], v13 offset:128
    ds_read_b64_tr_b16 v[26:27], v13 offset:1920
    ds_read_b64_tr_b16 v[28:29], v13 offset:256
    ds_read_b64_tr_b16 v[30:31], v13 offset:2048
    ds_read_b128 v[112:115], v11 offset:32
    ds_read_b64_tr_b16 v[116:117], v13 offset:7168
    ds_read_b64_tr_b16 v[118:119], v13 offset:8960
    ds_read_b64_tr_b16 v[120:121], v13 offset:7296
    ds_read_b64_tr_b16 v[122:123], v13 offset:9088
    ds_read_b64_tr_b16 v[124:125], v13 offset:7424
    ds_read_b64_tr_b16 v[126:127], v13 offset:9216
    s_waitcnt lgkmcnt(7)
    v_mfma_f32_32x32x16_bf16 v[64:79], v[20:23], v[16:19], v[64:79]
    v_mfma_f32_32x32x16_bf16 v[80:95], v[24:27], v[16:19], v[80:95]
    v_mfma_f32_32x32x16_bf16 v[96:111], v[16:19], v[28:31], v[96:111]
    ds_read_b128 v[16:19], v11 offset:64
    ds_read_b64_tr_b16 v[20:21], v13 offset:14336
    ds_read_b64_tr_b16 v[22:23], v13 offset:16128
    ds_read_b64_tr_b16 v[24:25], v13 offset:14464
    ds_read_b64_tr_b16 v[26:27], v13 offset:16256
    ds_read_b64_tr_b16 v[28:29], v13 offset:14592
    ds_read_b64_tr_b16 v[30:31], v13 offset:16384
    s_waitcnt lgkmcnt(7)
    v_mfma_f32_32x32x16_bf16 v[64:79], v[116:119], v[112:115], v[64:79]
    v_mfma_f32_32x32x16_bf16 v[80:95], v[120:123], v[112:115], v[80:95]
    v_mfma_f32_32x32x16_bf16 v[96:111], v[112:115], v[124:127], v[96:111]
    ds_read_b128 v[112:115], v11 offset:96
    ds_read_b64_tr_b16 v[116:117], v13 offset:21504
    ds_read_b64_tr_b16 v[118:119], v13 offset:23296
    ds_read_b64_tr_b16 v[120:121], v13 offset:21632
    ds_read_b64_tr_b16 v[122:123], v13 offset:23424
    ds_read_b64_tr_b16 v[124:125], v13 offset:21760
    ds_read_b64_tr_b16 v[126:127], v13 offset:23552
    s_waitcnt lgkmcnt(7)
    v_mfma_f32_32x32x16_bf16 v[64:79], v[20:23], v[16:19], v[64:79]
    v_mfma_f32_32x32x16_bf16 v[80:95], v[24:27], v[16:19], v[80:95]
    v_mfma_f32_32x32x16_bf16 v[96:111], v[16:19], v[28:31], v[96:111]
    s_waitcnt lgkmcnt(0)
    v_mfma_f32_32x32x16_bf16 v[64:79], v[116:119], v[112:115], v[64:79]
    v_mfma_f32_32x32x16_bf16 v[80:95], v[120:123], v[112:115], v[80:95]
    v_mfma_f32_32x32x16_bf16 v[96:111], v[112:115], v[124:127], v[96:111]
    s_waitcnt vmcnt(0)
    ds_write_b128 v6, v[224:227] offset:37888
    ds_write_b128 v6, v[228:231] offset:52224
    ds_write_b128 v6, v[232:235] offset:38016
    ds_write_b128 v6, v[236:239] offset:52352
    ds_write_b128 v6, v[240:243] offset:38144
    ds_write_b128 v6, v[244:247] offset:52480
    ds_write_b128 v8, v[248:251] offset:37888
    ds_write_b128 v8, v[252:255] offset:42496
    s_waitcnt lgkmcnt(0)
    s_barrier
    ds_read_b128 v[16:19], v11 offset:37888
    ds_read_b64_tr_b16 v[20:21], v13 offset:37888
    ds_read_b64_tr_b16 v[22:23], v13 offset:39680
    ds_read_b64_tr_b16 v[24:25], v13 offset:38016
    ds_read_b64_tr_b16 v[26:27], v13 offset:39808
    ds_read_b64_tr_b16 v[28:29], v13 offset:38144
    ds_read_b64_tr_b16 v[30:31], v13 offset:39936
    ds_read_b128 v[112:115], v11 offset:37920
    ds_read_b64_tr_b16 v[116:117], v13 offset:45056
    ds_read_b64_tr_b16 v[118:119], v13 offset:46848
    ds_read_b64_tr_b16 v[120:121], v13 offset:45184
    ds_read_b64_tr_b16 v[122:123], v13 offset:46976
    ds_read_b64_tr_b16 v[124:125], v13 offset:45312
    ds_read_b64_tr_b16 v[126:127], v13 offset:47104
    s_waitcnt lgkmcnt(7)
    v_mfma_f32_32x32x16_bf16 v[64:79], v[20:23], v[16:19], v[64:79]
    v_mfma_f32_32x32x16_bf16 v[80:95], v[24:27], v[16:19], v[80:95]
    v_mfma_f32_32x32x16_bf16 v[96:111], v[16:19], v[28:31], v[96:111]
    ds_read_b128 v[16:19], v11 offset:37952
    ds_read_b64_tr_b16 v[20:21], v13 offset:52224
    ds_read_b64_tr_b16 v[22:23], v13 offset:54016
    ds_read_b64_tr_b16 v[24:25], v13 offset:52352
    ds_read_b64_tr_b16 v[26:27], v13 offset:54144
    ds_read_b64_tr_b16 v[28:29], v13 offset:52480
    ds_read_b64_tr_b16 v[30:31], v13 offset:54272
    s_waitcnt lgkmcnt(7)
    v_mfma_f32_32x32x16_bf16 v[64:79], v[116:119], v[112:115], v[64:79]
    v_mfma_f32_32x32x16_bf16 v[80:95], v[120:123], v[112:115], v[80:95]
    v_mfma_f32_32x32x16_bf16 v[96:111], v[112:115], v[124:127], v[96:111]
    ds_read_b128 v[112:115], v11 offset:37984
    ds_read_b64_tr_b16 v[116:117], v13 offset:59392
    ds_read_b64_tr_b16 v[118:119], v13 offset:61184
    ds_read_b64_tr_b16 v[120:121], v13 offset:59520
    ds_read_b64_tr_b16 v[122:123], v13 offset:61312
    ds_read_b64_tr_b16 v[124:125], v13 offset:59648
    ds_read_b64_tr_b16 v[126:127], v13 offset:61440
    s_waitcnt lgkmcnt(7)
    v_mfma_f32_32x32x16_bf16 v[64:79], v[20:23], v[16:19], v[64:79]
    v_mfma_f32_32x32x16_bf16 v[80:95], v[24:27], v[16:19], v[80:95]
    v_mfma_f32_32x32x16_bf16 v[96:111], v[16:19], v[28:31], v[96:111]
    s_waitcnt lgkmcnt(0)
    v_mfma_f32_32x32x16_bf16 v[64:79], v[116:119], v[112:115], v[64:79]
    v_mfma_f32_32x32x16_bf16 v[80:95], v[120:123], v[112:115], v[80:95]
    v_mfma_f32_32x32x16_bf16 v[96:111], v[112:115], v[124:127], v[96:111]
    s_nop 15
    s_nop 15
    s_lshl_b32 s40, s34, 2
    s_lshl_b32 s41, s39, 1
    s_add_u32 s40, s40, s41
    s_lshl_b32 s41, s33, 6
    s_lshl_b32 s42, s38, 5
    s_add_u32 s41, s41, s42
    v_add_u32 v3, s41, v9
    v_lshlrev_b32 v3, 5, v3
    v_lshlrev_b32 v4, 4, v10
    v_add_u32 v3, v3, v4
    s_lshl_b32 s42, s40, 16
    v_add_u32 v3, s42, v3
    s_mov_b32 s43, 65536
    s_mov_b32 s44, 2097152
    s_mov_b32 s45, 2162688
    v_cvt_pk_bf16_f32 v16, v64, v65
    v_cvt_pk_bf16_f32 v17, v66, v67
    v_cvt_pk_bf16_f32 v18, v68, v69
    v_cvt_pk_bf16_f32 v19, v70, v71
    v_cvt_pk_bf16_f32 v20, v72, v73
    v_cvt_pk_bf16_f32 v21, v74, v75
    v_cvt_pk_bf16_f32 v22, v76, v77
    v_cvt_pk_bf16_f32 v23, v78, v79
    buffer_store_dwordx4 v[16:19], v3, s[20:23], 0 offen
    buffer_store_dwordx4 v[20:23], v3, s[20:23], s43 offen
    s_nop 1
    v_cvt_pk_bf16_f32 v16, v80, v81
    v_cvt_pk_bf16_f32 v17, v82, v83
    v_cvt_pk_bf16_f32 v18, v84, v85
    v_cvt_pk_bf16_f32 v19, v86, v87
    v_cvt_pk_bf16_f32 v20, v88, v89
    v_cvt_pk_bf16_f32 v21, v90, v91
    v_cvt_pk_bf16_f32 v22, v92, v93
    v_cvt_pk_bf16_f32 v23, v94, v95
    buffer_store_dwordx4 v[16:19], v3, s[20:23], s44 offen
    buffer_store_dwordx4 v[20:23], v3, s[20:23], s45 offen
    s_nop 1
    v_lshrrev_b32 v3, 4, v9
    v_lshlrev_b32 v3, 16, v3
    v_and_b32 v4, 15, v9
    v_lshlrev_b32 v4, 6, v4
    v_add_u32 v3, v3, v4
    v_lshlrev_b32 v4, 4, v10
    v_add_u32 v3, v3, v4
    s_lshl_b32 s41, s33, 1
    s_add_u32 s41, s41, s38
    s_lshl_b32 s41, s41, 10
    s_lshl_b32 s42, s40, 16
    s_add_u32 s41, s41, s42
    s_add_u32 s41, s41, 4194304
    v_cvt_pk_bf16_f32 v16, v96, v97
    v_cvt_pk_bf16_f32 v17, v98, v99
    v_cvt_pk_bf16_f32 v18, v100, v101
    v_cvt_pk_bf16_f32 v19, v102, v103
    v_cvt_pk_bf16_f32 v20, v104, v105
    v_cvt_pk_bf16_f32 v21, v106, v107
    v_cvt_pk_bf16_f32 v22, v108, v109
    v_cvt_pk_bf16_f32 v23, v110, v111
    buffer_store_dwordx4 v[16:19], v3, s[20:23], s41 offen
    buffer_store_dwordx4 v[20:23], v3, s[20:23], s41 offen offset:32
    s_branch L_k1_end
L_k1_mod:
    s_load_dwordx2 s[4:5], s[0:1], 80
    s_load_dwordx2 s[6:7], s[0:1], 40
    s_load_dwordx2 s[8:9], s[0:1], 48
    v_lshrrev_b32 v1, 6, v0
    s_nop 0
    v_readfirstlane_b32 s35, v1
    v_and_b32 v2, 63, v0
    s_waitcnt lgkmcnt(0)
    s_mov_b32 s12, s6
    s_and_b32 s13, s7, 0xffff
    s_mov_b32 s14, 1409024
    s_mov_b32 s15, 0x00020000
    s_mov_b32 s16, s8
    s_and_b32 s17, s9, 0xffff
    s_mov_b32 s18, 1409024
    s_mov_b32 s19, 0x00020000
    s_add_u32 s20, s4, 10485760
    s_addc_u32 s21, s5, 0
    s_and_b32 s21, s21, 0xffff
    s_mov_b32 s22, 8192
    s_mov_b32 s23, 0x00020000
    s_mov_b32 s24, s4
    s_and_b32 s25, s5, 0xffff
    s_mov_b32 s26, 2097152
    s_mov_b32 s27, 0x00020000
    s_add_u32 s28, s4, 10551296
    s_addc_u32 s29, s5, 0
    s_and_b32 s29, s29, 0xffff
    s_mov_b32 s30, 88064
    s_mov_b32 s31, 0x00020000
    v_lshlrev_b32 v3, 4, v2
    v_add_u32 v9, 4096, v3
    buffer_load_dwordx4 v[128:131], v3, s[20:23], 0 offen offset:0
    buffer_load_dwordx4 v[132:135], v3, s[20:23], 0 offen offset:1024
    buffer_load_dwordx4 v[136:139], v3, s[20:23], 0 offen offset:2048
    buffer_load_dwordx4 v[140:143], v3, s[20:23], 0 offen offset:3072
    buffer_load_dwordx4 v[144:147], v9, s[20:23], 0 offen offset:0
    buffer_load_dwordx4 v[148:151], v9, s[20:23], 0 offen offset:1024
    buffer_load_dwordx4 v[152:155], v9, s[20:23], 0 offen offset:2048
    buffer_load_dwordx4 v[156:159], v9, s[20:23], 0 offen offset:3072
    v_and_b32 v4, 3, v0
    v_lshlrev_b32 v4, 4, v4
    v_lshrrev_b32 v5, 2, v0
    s_mov_b32 s36, 2752
    v_mul_lo_u32 v6, v5, s36
    v_add_u32 v6, v6, v4
    v_lshlrev_b32 v7, 6, v5
    v_add_u32 v7, v7, v4
    s_lshl_b32 s37, s2, 6
    buffer_load_dwordx4 v[64:67], v6, s[12:15], s37 offen
    buffer_load_dwordx4 v[96:99], v6, s[16:19], s37 offen
    s_add_u32 s37, s37, 176128
    buffer_load_dwordx4 v[68:71], v6, s[12:15], s37 offen
    buffer_load_dwordx4 v[100:103], v6, s[16:19], s37 offen
    s_add_u32 s37, s37, 176128
    buffer_load_dwordx4 v[72:75], v6, s[12:15], s37 offen
    buffer_load_dwordx4 v[104:107], v6, s[16:19], s37 offen
    s_add_u32 s37, s37, 176128
    buffer_load_dwordx4 v[76:79], v6, s[12:15], s37 offen
    buffer_load_dwordx4 v[108:111], v6, s[16:19], s37 offen
    s_add_u32 s37, s37, 176128
    buffer_load_dwordx4 v[80:83], v6, s[12:15], s37 offen
    buffer_load_dwordx4 v[112:115], v6, s[16:19], s37 offen
    s_add_u32 s37, s37, 176128
    buffer_load_dwordx4 v[84:87], v6, s[12:15], s37 offen
    buffer_load_dwordx4 v[116:119], v6, s[16:19], s37 offen
    s_add_u32 s37, s37, 176128
    buffer_load_dwordx4 v[88:91], v6, s[12:15], s37 offen
    buffer_load_dwordx4 v[120:123], v6, s[16:19], s37 offen
    s_add_u32 s37, s37, 176128
    buffer_load_dwordx4 v[92:95], v6, s[12:15], s37 offen
    buffer_load_dwordx4 v[124:127], v6, s[16:19], s37 offen
    s_add_u32 s37, s37, 176128
    s_cmp_lg_u32 s35, 0
    s_cbranch_scc1 L_m1_stage
    s_waitcnt vmcnt(16)
    v_lshlrev_b32 v8, 2, v2
    s_mov_b32 s38, 0x80000000
    v_ashrrev_i32 v9, 31, v128
    v_or_b32 v9, s38, v9
    v_xor_b32 v128, v128, v9
    v_and_b32 v128, 0xffff0000, v128
    v_sub_u32 v9, 2047, v8
    v_or_b32 v128, v128, v9
    v_ashrrev_i32 v9, 31, v129
    v_or_b32 v9, s38, v9
    v_xor_b32 v129, v129, v9
    v_and_b32 v129, 0xffff0000, v129
    v_sub_u32 v9, 2046, v8
    v_or_b32 v129, v129, v9
    v_ashrrev_i32 v9, 31, v130
    v_or_b32 v9, s38, v9
    v_xor_b32 v130, v130, v9
    v_and_b32 v130, 0xffff0000, v130
    v_sub_u32 v9, 2045, v8
    v_or_b32 v130, v130, v9
    v_ashrrev_i32 v9, 31, v131
    v_or_b32 v9, s38, v9
    v_xor_b32 v131, v131, v9
    v_and_b32 v131, 0xffff0000, v131
    v_sub_u32 v9, 2044, v8
    v_or_b32 v131, v131, v9
    v_ashrrev_i32 v9, 31, v132
    v_or_b32 v9, s38, v9
    v_xor_b32 v132, v132, v9
    v_and_b32 v132, 0xffff0000, v132
    v_sub_u32 v9, 1791, v8
    v_or_b32 v132, v132, v9
    v_ashrrev_i32 v9, 31, v133
    v_or_b32 v9, s38, v9
    v_xor_b32 v133, v133, v9
    v_and_b32 v133, 0xffff0000, v133
    v_sub_u32 v9, 1790, v8
    v_or_b32 v133, v133, v9
    v_ashrrev_i32 v9, 31, v134
    v_or_b32 v9, s38, v9
    v_xor_b32 v134, v134, v9
    v_and_b32 v134, 0xffff0000, v134
    v_sub_u32 v9, 1789, v8
    v_or_b32 v134, v134, v9
    v_ashrrev_i32 v9, 31, v135
    v_or_b32 v9, s38, v9
    v_xor_b32 v135, v135, v9
    v_and_b32 v135, 0xffff0000, v135
    v_sub_u32 v9, 1788, v8
    v_or_b32 v135, v135, v9
    v_ashrrev_i32 v9, 31, v136
    v_or_b32 v9, s38, v9
    v_xor_b32 v136, v136, v9
    v_and_b32 v136, 0xffff0000, v136
    v_sub_u32 v9, 1535, v8
    v_or_b32 v136, v136, v9
    v_ashrrev_i32 v9, 31, v137
    v_or_b32 v9, s38, v9
    v_xor_b32 v137, v137, v9
    v_and_b32 v137, 0xffff0000, v137
    v_sub_u32 v9, 1534, v8
    v_or_b32 v137, v137, v9
    v_ashrrev_i32 v9, 31, v138
    v_or_b32 v9, s38, v9
    v_xor_b32 v138, v138, v9
    v_and_b32 v138, 0xffff0000, v138
    v_sub_u32 v9, 1533, v8
    v_or_b32 v138, v138, v9
    v_ashrrev_i32 v9, 31, v139
    v_or_b32 v9, s38, v9
    v_xor_b32 v139, v139, v9
    v_and_b32 v139, 0xffff0000, v139
    v_sub_u32 v9, 1532, v8
    v_or_b32 v139, v139, v9
    v_ashrrev_i32 v9, 31, v140
    v_or_b32 v9, s38, v9
    v_xor_b32 v140, v140, v9
    v_and_b32 v140, 0xffff0000, v140
    v_sub_u32 v9, 1279, v8
    v_or_b32 v140, v140, v9
    v_ashrrev_i32 v9, 31, v141
    v_or_b32 v9, s38, v9
    v_xor_b32 v141, v141, v9
    v_and_b32 v141, 0xffff0000, v141
    v_sub_u32 v9, 1278, v8
    v_or_b32 v141, v141, v9
    v_ashrrev_i32 v9, 31, v142
    v_or_b32 v9, s38, v9
    v_xor_b32 v142, v142, v9
    v_and_b32 v142, 0xffff0000, v142
    v_sub_u32 v9, 1277, v8
    v_or_b32 v142, v142, v9
    v_ashrrev_i32 v9, 31, v143
    v_or_b32 v9, s38, v9
    v_xor_b32 v143, v143, v9
    v_and_b32 v143, 0xffff0000, v143
    v_sub_u32 v9, 1276, v8
    v_or_b32 v143, v143, v9
    v_ashrrev_i32 v9, 31, v144
    v_or_b32 v9, s38, v9
    v_xor_b32 v144, v144, v9
    v_and_b32 v144, 0xffff0000, v144
    v_sub_u32 v9, 1023, v8
    v_or_b32 v144, v144, v9
    v_ashrrev_i32 v9, 31, v145
    v_or_b32 v9, s38, v9
    v_xor_b32 v145, v145, v9
    v_and_b32 v145, 0xffff0000, v145
    v_sub_u32 v9, 1022, v8
    v_or_b32 v145, v145, v9
    v_ashrrev_i32 v9, 31, v146
    v_or_b32 v9, s38, v9
    v_xor_b32 v146, v146, v9
    v_and_b32 v146, 0xffff0000, v146
    v_sub_u32 v9, 1021, v8
    v_or_b32 v146, v146, v9
    v_ashrrev_i32 v9, 31, v147
    v_or_b32 v9, s38, v9
    v_xor_b32 v147, v147, v9
    v_and_b32 v147, 0xffff0000, v147
    v_sub_u32 v9, 1020, v8
    v_or_b32 v147, v147, v9
    v_ashrrev_i32 v9, 31, v148
    v_or_b32 v9, s38, v9
    v_xor_b32 v148, v148, v9
    v_and_b32 v148, 0xffff0000, v148
    v_sub_u32 v9, 767, v8
    v_or_b32 v148, v148, v9
    v_ashrrev_i32 v9, 31, v149
    v_or_b32 v9, s38, v9
    v_xor_b32 v149, v149, v9
    v_and_b32 v149, 0xffff0000, v149
    v_sub_u32 v9, 766, v8
    v_or_b32 v149, v149, v9
    v_ashrrev_i32 v9, 31, v150
    v_or_b32 v9, s38, v9
    v_xor_b32 v150, v150, v9
    v_and_b32 v150, 0xffff0000, v150
    v_sub_u32 v9, 765, v8
    v_or_b32 v150, v150, v9
    v_ashrrev_i32 v9, 31, v151
    v_or_b32 v9, s38, v9
    v_xor_b32 v151, v151, v9
    v_and_b32 v151, 0xffff0000, v151
    v_sub_u32 v9, 764, v8
    v_or_b32 v151, v151, v9
    v_ashrrev_i32 v9, 31, v152
    v_or_b32 v9, s38, v9
    v_xor_b32 v152, v152, v9
    v_and_b32 v152, 0xffff0000, v152
    v_sub_u32 v9, 511, v8
    v_or_b32 v152, v152, v9
    v_ashrrev_i32 v9, 31, v153
    v_or_b32 v9, s38, v9
    v_xor_b32 v153, v153, v9
    v_and_b32 v153, 0xffff0000, v153
    v_sub_u32 v9, 510, v8
    v_or_b32 v153, v153, v9
    v_ashrrev_i32 v9, 31, v154
    v_or_b32 v9, s38, v9
    v_xor_b32 v154, v154, v9
    v_and_b32 v154, 0xffff0000, v154
    v_sub_u32 v9, 509, v8
    v_or_b32 v154, v154, v9
    v_ashrrev_i32 v9, 31, v155
    v_or_b32 v9, s38, v9
    v_xor_b32 v155, v155, v9
    v_and_b32 v155, 0xffff0000, v155
    v_sub_u32 v9, 508, v8
    v_or_b32 v155, v155, v9
    v_ashrrev_i32 v9, 31, v156
    v_or_b32 v9, s38, v9
    v_xor_b32 v156, v156, v9
    v_and_b32 v156, 0xffff0000, v156
    v_sub_u32 v9, 255, v8
    v_or_b32 v156, v156, v9
    v_ashrrev_i32 v9, 31, v157
    v_or_b32 v9, s38, v9
    v_xor_b32 v157, v157, v9
    v_and_b32 v157, 0xffff0000, v157
    v_sub_u32 v9, 254, v8
    v_or_b32 v157, v157, v9
    v_ashrrev_i32 v9, 31, v158
    v_or_b32 v9, s38, v9
    v_xor_b32 v158, v158, v9
    v_and_b32 v158, 0xffff0000, v158
    v_sub_u32 v9, 253, v8
    v_or_b32 v158, v158, v9
    v_ashrrev_i32 v9, 31, v159
    v_or_b32 v9, s38, v9
    v_xor_b32 v159, v159, v9
    v_and_b32 v159, 0xffff0000, v159
    v_sub_u32 v9, 252, v8
    v_or_b32 v159, v159, v9
    v_max3_u32 v10, v128, v129, v130
    v_max3_u32 v10, v10, v131, v132
    v_max3_u32 v10, v10, v133, v134
    v_max3_u32 v10, v10, v135, v136
    v_max3_u32 v10, v10, v137, v138
    v_max3_u32 v10, v10, v139, v140
    v_max3_u32 v10, v10, v141, v142
    v_max3_u32 v10, v10, v143, v144
    v_max3_u32 v10, v10, v145, v146
    v_max3_u32 v10, v10, v147, v148
    v_max3_u32 v10, v10, v149, v150
    v_max3_u32 v10, v10, v151, v152
    v_max3_u32 v10, v10, v153, v154
    v_max3_u32 v10, v10, v155, v156
    v_max3_u32 v10, v10, v157, v158
    v_max_u32 v10, v10, v159
    s_nop 1
    v_max_u32_dpp v10, v10, v10 row_ror:8 row_mask:0xf bank_mask:0xf
    s_nop 1
    v_max_u32_dpp v10, v10, v10 row_ror:4 row_mask:0xf bank_mask:0xf
    s_nop 1
    v_max_u32_dpp v10, v10, v10 row_ror:2 row_mask:0xf bank_mask:0xf
    s_nop 1
    v_max_u32_dpp v10, v10, v10 row_ror:1 row_mask:0xf bank_mask:0xf
    v_mov_b32 v11, v10
    s_nop 1
    v_permlane16_swap_b32 v10, v11
    v_max_u32 v10, v10, v11
    v_mov_b32 v11, v10
    s_nop 1
    v_permlane32_swap_b32 v10, v11
    v_max_u32 v10, v10, v11
    s_nop 0
    v_readfirstlane_b32 s39, v10
    s_nop 1
    s_mov_b32 s40, s39
    s_mov_b32 s60, s40
    v_sub_u32 v128, v128, v10
    v_sub_u32 v129, v129, v10
    v_sub_u32 v130, v130, v10
    v_sub_u32 v131, v131, v10
    v_sub_u32 v132, v132, v10
    v_sub_u32 v133, v133, v10
    v_sub_u32 v134, v134, v10
    v_sub_u32 v135, v135, v10
    v_sub_u32 v136, v136, v10
    v_sub_u32 v137, v137, v10
    v_sub_u32 v138, v138, v10
    v_sub_u32 v139, v139, v10
    v_sub_u32 v140, v140, v10
    v_sub_u32 v141, v141, v10
    v_sub_u32 v142, v142, v10
    v_sub_u32 v143, v143, v10
    v_sub_u32 v144, v144, v10
    v_sub_u32 v145, v145, v10
    v_sub_u32 v146, v146, v10
    v_sub_u32 v147, v147, v10
    v_sub_u32 v148, v148, v10
    v_sub_u32 v149, v149, v10
    v_sub_u32 v150, v150, v10
    v_sub_u32 v151, v151, v10
    v_sub_u32 v152, v152, v10
    v_sub_u32 v153, v153, v10
    v_sub_u32 v154, v154, v10
    v_sub_u32 v155, v155, v10
    v_sub_u32 v156, v156, v10
    v_sub_u32 v157, v157, v10
    v_sub_u32 v158, v158, v10
    v_sub_u32 v159, v159, v10
    v_max3_u32 v10, v128, v129, v130
    v_max3_u32 v10, v10, v131, v132
    v_max3_u32 v10, v10, v133, v134
    v_max3_u32 v10, v10, v135, v136
    v_max3_u32 v10, v10, v137, v138
    v_max3_u32 v10, v10, v139, v140
    v_max3_u32 v10, v10, v141, v142
    v_max3_u32 v10, v10, v143, v144
    v_max3_u32 v10, v10, v145, v146
    v_max3_u32 v10, v10, v147, v148
    v_max3_u32 v10, v10, v149, v150
    v_max3_u32 v10, v10, v151, v152
    v_max3_u32 v10, v10, v153, v154
    v_max3_u32 v10, v10, v155, v156
    v_max3_u32 v10, v10, v157, v158
    v_max_u32 v10, v10, v159
    s_nop 1
    v_max_u32_dpp v10, v10, v10 row_ror:8 row_mask:0xf bank_mask:0xf
    s_nop 1
    v_max_u32_dpp v10, v10, v10 row_ror:4 row_mask:0xf bank_mask:0xf
    s_nop 1
    v_max_u32_dpp v10, v10, v10 row_ror:2 row_mask:0xf bank_mask:0xf
    s_nop 1
    v_max_u32_dpp v10, v10, v10 row_ror:1 row_mask:0xf bank_mask:0xf
    v_mov_b32 v11, v10
    s_nop 1
    v_permlane16_swap_b32 v10, v11
    v_max_u32 v10, v10, v11
    v_mov_b32 v11, v10
    s_nop 1
    v_permlane32_swap_b32 v10, v11
    v_max_u32 v10, v10, v11
    s_nop 0
    v_readfirstlane_b32 s39, v10
    s_nop 1
    s_add_u32 s40, s40, s39
    s_mov_b32 s61, s40
    v_sub_u32 v128, v128, v10
    v_sub_u32 v129, v129, v10
    v_sub_u32 v130, v130, v10
    v_sub_u32 v131, v131, v10
    v_sub_u32 v132, v132, v10
    v_sub_u32 v133, v133, v10
    v_sub_u32 v134, v134, v10
    v_sub_u32 v135, v135, v10
    v_sub_u32 v136, v136, v10
    v_sub_u32 v137, v137, v10
    v_sub_u32 v138, v138, v10
    v_sub_u32 v139, v139, v10
    v_sub_u32 v140, v140, v10
    v_sub_u32 v141, v141, v10
    v_sub_u32 v142, v142, v10
    v_sub_u32 v143, v143, v10
    v_sub_u32 v144, v144, v10
    v_sub_u32 v145, v145, v10
    v_sub_u32 v146, v146, v10
    v_sub_u32 v147, v147, v10
    v_sub_u32 v148, v148, v10
    v_sub_u32 v149, v149, v10
    v_sub_u32 v150, v150, v10
    v_sub_u32 v151, v151, v10
    v_sub_u32 v152, v152, v10
    v_sub_u32 v153, v153, v10
    v_sub_u32 v154, v154, v10
    v_sub_u32 v155, v155, v10
    v_sub_u32 v156, v156, v10
    v_sub_u32 v157, v157, v10
    v_sub_u32 v158, v158, v10
    v_sub_u32 v159, v159, v10
    v_max3_u32 v10, v128, v129, v130
    v_max3_u32 v10, v10, v131, v132
    v_max3_u32 v10, v10, v133, v134
    v_max3_u32 v10, v10, v135, v136
    v_max3_u32 v10, v10, v137, v138
    v_max3_u32 v10, v10, v139, v140
    v_max3_u32 v10, v10, v141, v142
    v_max3_u32 v10, v10, v143, v144
    v_max3_u32 v10, v10, v145, v146
    v_max3_u32 v10, v10, v147, v148
    v_max3_u32 v10, v10, v149, v150
    v_max3_u32 v10, v10, v151, v152
    v_max3_u32 v10, v10, v153, v154
    v_max3_u32 v10, v10, v155, v156
    v_max3_u32 v10, v10, v157, v158
    v_max_u32 v10, v10, v159
    s_nop 1
    v_max_u32_dpp v10, v10, v10 row_ror:8 row_mask:0xf bank_mask:0xf
    s_nop 1
    v_max_u32_dpp v10, v10, v10 row_ror:4 row_mask:0xf bank_mask:0xf
    s_nop 1
    v_max_u32_dpp v10, v10, v10 row_ror:2 row_mask:0xf bank_mask:0xf
    s_nop 1
    v_max_u32_dpp v10, v10, v10 row_ror:1 row_mask:0xf bank_mask:0xf
    v_mov_b32 v11, v10
    s_nop 1
    v_permlane16_swap_b32 v10, v11
    v_max_u32 v10, v10, v11
    v_mov_b32 v11, v10
    s_nop 1
    v_permlane32_swap_b32 v10, v11
    v_max_u32 v10, v10, v11
    s_nop 0
    v_readfirstlane_b32 s39, v10
    s_nop 1
    s_add_u32 s40, s40, s39
    s_mov_b32 s62, s40
    v_sub_u32 v128, v128, v10
    v_sub_u32 v129, v129, v10
    v_sub_u32 v130, v130, v10
    v_sub_u32 v131, v131, v10
    v_sub_u32 v132, v132, v10
    v_sub_u32 v133, v133, v10
    v_sub_u32 v134, v134, v10
    v_sub_u32 v135, v135, v10
    v_sub_u32 v136, v136, v10
    v_sub_u32 v137, v137, v10
    v_sub_u32 v138, v138, v10
    v_sub_u32 v139, v139, v10
    v_sub_u32 v140, v140, v10
    v_sub_u32 v141, v141, v10
    v_sub_u32 v142, v142, v10
    v_sub_u32 v143, v143, v10
    v_sub_u32 v144, v144, v10
    v_sub_u32 v145, v145, v10
    v_sub_u32 v146, v146, v10
    v_sub_u32 v147, v147, v10
    v_sub_u32 v148, v148, v10
    v_sub_u32 v149, v149, v10
    v_sub_u32 v150, v150, v10
    v_sub_u32 v151, v151, v10
    v_sub_u32 v152, v152, v10
    v_sub_u32 v153, v153, v10
    v_sub_u32 v154, v154, v10
    v_sub_u32 v155, v155, v10
    v_sub_u32 v156, v156, v10
    v_sub_u32 v157, v157, v10
    v_sub_u32 v158, v158, v10
    v_sub_u32 v159, v159, v10
    v_max3_u32 v10, v128, v129, v130
    v_max3_u32 v10, v10, v131, v132
    v_max3_u32 v10, v10, v133, v134
    v_max3_u32 v10, v10, v135, v136
    v_max3_u32 v10, v10, v137, v138
    v_max3_u32 v10, v10, v139, v140
    v_max3_u32 v10, v10, v141, v142
    v_max3_u32 v10, v10, v143, v144
    v_max3_u32 v10, v10, v145, v146
    v_max3_u32 v10, v10, v147, v148
    v_max3_u32 v10, v10, v149, v150
    v_max3_u32 v10, v10, v151, v152
    v_max3_u32 v10, v10, v153, v154
    v_max3_u32 v10, v10, v155, v156
    v_max3_u32 v10, v10, v157, v158
    v_max_u32 v10, v10, v159
    s_nop 1
    v_max_u32_dpp v10, v10, v10 row_ror:8 row_mask:0xf bank_mask:0xf
    s_nop 1
    v_max_u32_dpp v10, v10, v10 row_ror:4 row_mask:0xf bank_mask:0xf
    s_nop 1
    v_max_u32_dpp v10, v10, v10 row_ror:2 row_mask:0xf bank_mask:0xf
    s_nop 1
    v_max_u32_dpp v10, v10, v10 row_ror:1 row_mask:0xf bank_mask:0xf
    v_mov_b32 v11, v10
    s_nop 1
    v_permlane16_swap_b32 v10, v11
    v_max_u32 v10, v10, v11
    v_mov_b32 v11, v10
    s_nop 1
    v_permlane32_swap_b32 v10, v11
    v_max_u32 v10, v10, v11
    s_nop 0
    v_readfirstlane_b32 s39, v10
    s_nop 1
    s_add_u32 s40, s40, s39
    s_mov_b32 s63, s40
    v_sub_u32 v128, v128, v10
    v_sub_u32 v129, v129, v10
    v_sub_u32 v130, v130, v10
    v_sub_u32 v131, v131, v10
    v_sub_u32 v132, v132, v10
    v_sub_u32 v133, v133, v10
    v_sub_u32 v134, v134, v10
    v_sub_u32 v135, v135, v10
    v_sub_u32 v136, v136, v10
    v_sub_u32 v137, v137, v10
    v_sub_u32 v138, v138, v10
    v_sub_u32 v139, v139, v10
    v_sub_u32 v140, v140, v10
    v_sub_u32 v141, v141, v10
    v_sub_u32 v142, v142, v10
    v_sub_u32 v143, v143, v10
    v_sub_u32 v144, v144, v10
    v_sub_u32 v145, v145, v10
    v_sub_u32 v146, v146, v10
    v_sub_u32 v147, v147, v10
    v_sub_u32 v148, v148, v10
    v_sub_u32 v149, v149, v10
    v_sub_u32 v150, v150, v10
    v_sub_u32 v151, v151, v10
    v_sub_u32 v152, v152, v10
    v_sub_u32 v153, v153, v10
    v_sub_u32 v154, v154, v10
    v_sub_u32 v155, v155, v10
    v_sub_u32 v156, v156, v10
    v_sub_u32 v157, v157, v10
    v_sub_u32 v158, v158, v10
    v_sub_u32 v159, v159, v10
    v_max3_u32 v10, v128, v129, v130
    v_max3_u32 v10, v10, v131, v132
    v_max3_u32 v10, v10, v133, v134
    v_max3_u32 v10, v10, v135, v136
    v_max3_u32 v10, v10, v137, v138
    v_max3_u32 v10, v10, v139, v140
    v_max3_u32 v10, v10, v141, v142
    v_max3_u32 v10, v10, v143, v144
    v_max3_u32 v10, v10, v145, v146
    v_max3_u32 v10, v10, v147, v148
    v_max3_u32 v10, v10, v149, v150
    v_max3_u32 v10, v10, v151, v152
    v_max3_u32 v10, v10, v153, v154
    v_max3_u32 v10, v10, v155, v156
    v_max3_u32 v10, v10, v157, v158
    v_max_u32 v10, v10, v159
    s_nop 1
    v_max_u32_dpp v10, v10, v10 row_ror:8 row_mask:0xf bank_mask:0xf
    s_nop 1
    v_max_u32_dpp v10, v10, v10 row_ror:4 row_mask:0xf bank_mask:0xf
    s_nop 1
    v_max_u32_dpp v10, v10, v10 row_ror:2 row_mask:0xf bank_mask:0xf
    s_nop 1
    v_max_u32_dpp v10, v10, v10 row_ror:1 row_mask:0xf bank_mask:0xf
    v_mov_b32 v11, v10
    s_nop 1
    v_permlane16_swap_b32 v10, v11
    v_max_u32 v10, v10, v11
    v_mov_b32 v11, v10
    s_nop 1
    v_permlane32_swap_b32 v10, v11
    v_max_u32 v10, v10, v11
    s_nop 0
    v_readfirstlane_b32 s39, v10
    s_nop 1
    s_add_u32 s40, s40, s39
    s_mov_b32 s64, s40
    v_sub_u32 v128, v128, v10
    v_sub_u32 v129, v129, v10
    v_sub_u32 v130, v130, v10
    v_sub_u32 v131, v131, v10
    v_sub_u32 v132, v132, v10
    v_sub_u32 v133, v133, v10
    v_sub_u32 v134, v134, v10
    v_sub_u32 v135, v135, v10
    v_sub_u32 v136, v136, v10
    v_sub_u32 v137, v137, v10
    v_sub_u32 v138, v138, v10
    v_sub_u32 v139, v139, v10
    v_sub_u32 v140, v140, v10
    v_sub_u32 v141, v141, v10
    v_sub_u32 v142, v142, v10
    v_sub_u32 v143, v143, v10
    v_sub_u32 v144, v144, v10
    v_sub_u32 v145, v145, v10
    v_sub_u32 v146, v146, v10
    v_sub_u32 v147, v147, v10
    v_sub_u32 v148, v148, v10
    v_sub_u32 v149, v149, v10
    v_sub_u32 v150, v150, v10
    v_sub_u32 v151, v151, v10
    v_sub_u32 v152, v152, v10
    v_sub_u32 v153, v153, v10
    v_sub_u32 v154, v154, v10
    v_sub_u32 v155, v155, v10
    v_sub_u32 v156, v156, v10
    v_sub_u32 v157, v157, v10
    v_sub_u32 v158, v158, v10
    v_sub_u32 v159, v159, v10
    v_max3_u32 v10, v128, v129, v130
    v_max3_u32 v10, v10, v131, v132
    v_max3_u32 v10, v10, v133, v134
    v_max3_u32 v10, v10, v135, v136
    v_max3_u32 v10, v10, v137, v138
    v_max3_u32 v10, v10, v139, v140
    v_max3_u32 v10, v10, v141, v142
    v_max3_u32 v10, v10, v143, v144
    v_max3_u32 v10, v10, v145, v146
    v_max3_u32 v10, v10, v147, v148
    v_max3_u32 v10, v10, v149, v150
    v_max3_u32 v10, v10, v151, v152
    v_max3_u32 v10, v10, v153, v154
    v_max3_u32 v10, v10, v155, v156
    v_max3_u32 v10, v10, v157, v158
    v_max_u32 v10, v10, v159
    s_nop 1
    v_max_u32_dpp v10, v10, v10 row_ror:8 row_mask:0xf bank_mask:0xf
    s_nop 1
    v_max_u32_dpp v10, v10, v10 row_ror:4 row_mask:0xf bank_mask:0xf
    s_nop 1
    v_max_u32_dpp v10, v10, v10 row_ror:2 row_mask:0xf bank_mask:0xf
    s_nop 1
    v_max_u32_dpp v10, v10, v10 row_ror:1 row_mask:0xf bank_mask:0xf
    v_mov_b32 v11, v10
    s_nop 1
    v_permlane16_swap_b32 v10, v11
    v_max_u32 v10, v10, v11
    v_mov_b32 v11, v10
    s_nop 1
    v_permlane32_swap_b32 v10, v11
    v_max_u32 v10, v10, v11
    s_nop 0
    v_readfirstlane_b32 s39, v10
    s_nop 1
    s_add_u32 s40, s40, s39
    s_mov_b32 s65, s40
    v_sub_u32 v128, v128, v10
    v_sub_u32 v129, v129, v10
    v_sub_u32 v130, v130, v10
    v_sub_u32 v131, v131, v10
    v_sub_u32 v132, v132, v10
    v_sub_u32 v133, v133, v10
    v_sub_u32 v134, v134, v10
    v_sub_u32 v135, v135, v10
    v_sub_u32 v136, v136, v10
    v_sub_u32 v137, v137, v10
    v_sub_u32 v138, v138, v10
    v_sub_u32 v139, v139, v10
    v_sub_u32 v140, v140, v10
    v_sub_u32 v141, v141, v10
    v_sub_u32 v142, v142, v10
    v_sub_u32 v143, v143, v10
    v_sub_u32 v144, v144, v10
    v_sub_u32 v145, v145, v10
    v_sub_u32 v146, v146, v10
    v_sub_u32 v147, v147, v10
    v_sub_u32 v148, v148, v10
    v_sub_u32 v149, v149, v10
    v_sub_u32 v150, v150, v10
    v_sub_u32 v151, v151, v10
    v_sub_u32 v152, v152, v10
    v_sub_u32 v153, v153, v10
    v_sub_u32 v154, v154, v10
    v_sub_u32 v155, v155, v10
    v_sub_u32 v156, v156, v10
    v_sub_u32 v157, v157, v10
    v_sub_u32 v158, v158, v10
    v_sub_u32 v159, v159, v10
    v_max3_u32 v10, v128, v129, v130
    v_max3_u32 v10, v10, v131, v132
    v_max3_u32 v10, v10, v133, v134
    v_max3_u32 v10, v10, v135, v136
    v_max3_u32 v10, v10, v137, v138
    v_max3_u32 v10, v10, v139, v140
    v_max3_u32 v10, v10, v141, v142
    v_max3_u32 v10, v10, v143, v144
    v_max3_u32 v10, v10, v145, v146
    v_max3_u32 v10, v10, v147, v148
    v_max3_u32 v10, v10, v149, v150
    v_max3_u32 v10, v10, v151, v152
    v_max3_u32 v10, v10, v153, v154
    v_max3_u32 v10, v10, v155, v156
    v_max3_u32 v10, v10, v157, v158
    v_max_u32 v10, v10, v159
    s_nop 1
    v_max_u32_dpp v10, v10, v10 row_ror:8 row_mask:0xf bank_mask:0xf
    s_nop 1
    v_max_u32_dpp v10, v10, v10 row_ror:4 row_mask:0xf bank_mask:0xf
    s_nop 1
    v_max_u32_dpp v10, v10, v10 row_ror:2 row_mask:0xf bank_mask:0xf
    s_nop 1
    v_max_u32_dpp v10, v10, v10 row_ror:1 row_mask:0xf bank_mask:0xf
    v_mov_b32 v11, v10
    s_nop 1
    v_permlane16_swap_b32 v10, v11
    v_max_u32 v10, v10, v11
    v_mov_b32 v11, v10
    s_nop 1
    v_permlane32_swap_b32 v10, v11
    v_max_u32 v10, v10, v11
    s_nop 0
    v_readfirstlane_b32 s39, v10
    s_nop 1
    s_add_u32 s40, s40, s39
    s_mov_b32 s66, s40
    v_sub_u32 v128, v128, v10
    v_sub_u32 v129, v129, v10
    v_sub_u32 v130, v130, v10
    v_sub_u32 v131, v131, v10
    v_sub_u32 v132, v132, v10
    v_sub_u32 v133, v133, v10
    v_sub_u32 v134, v134, v10
    v_sub_u32 v135, v135, v10
    v_sub_u32 v136, v136, v10
    v_sub_u32 v137, v137, v10
    v_sub_u32 v138, v138, v10
    v_sub_u32 v139, v139, v10
    v_sub_u32 v140, v140, v10
    v_sub_u32 v141, v141, v10
    v_sub_u32 v142, v142, v10
    v_sub_u32 v143, v143, v10
    v_sub_u32 v144, v144, v10
    v_sub_u32 v145, v145, v10
    v_sub_u32 v146, v146, v10
    v_sub_u32 v147, v147, v10
    v_sub_u32 v148, v148, v10
    v_sub_u32 v149, v149, v10
    v_sub_u32 v150, v150, v10
    v_sub_u32 v151, v151, v10
    v_sub_u32 v152, v152, v10
    v_sub_u32 v153, v153, v10
    v_sub_u32 v154, v154, v10
    v_sub_u32 v155, v155, v10
    v_sub_u32 v156, v156, v10
    v_sub_u32 v157, v157, v10
    v_sub_u32 v158, v158, v10
    v_sub_u32 v159, v159, v10
    v_max3_u32 v10, v128, v129, v130
    v_max3_u32 v10, v10, v131, v132
    v_max3_u32 v10, v10, v133, v134
    v_max3_u32 v10, v10, v135, v136
    v_max3_u32 v10, v10, v137, v138
    v_max3_u32 v10, v10, v139, v140
    v_max3_u32 v10, v10, v141, v142
    v_max3_u32 v10, v10, v143, v144
    v_max3_u32 v10, v10, v145, v146
    v_max3_u32 v10, v10, v147, v148
    v_max3_u32 v10, v10, v149, v150
    v_max3_u32 v10, v10, v151, v152
    v_max3_u32 v10, v10, v153, v154
    v_max3_u32 v10, v10, v155, v156
    v_max3_u32 v10, v10, v157, v158
    v_max_u32 v10, v10, v159
    s_nop 1
    v_max_u32_dpp v10, v10, v10 row_ror:8 row_mask:0xf bank_mask:0xf
    s_nop 1
    v_max_u32_dpp v10, v10, v10 row_ror:4 row_mask:0xf bank_mask:0xf
    s_nop 1
    v_max_u32_dpp v10, v10, v10 row_ror:2 row_mask:0xf bank_mask:0xf
    s_nop 1
    v_max_u32_dpp v10, v10, v10 row_ror:1 row_mask:0xf bank_mask:0xf
    v_mov_b32 v11, v10
    s_nop 1
    v_permlane16_swap_b32 v10, v11
    v_max_u32 v10, v10, v11
    v_mov_b32 v11, v10
    s_nop 1
    v_permlane32_swap_b32 v10, v11
    v_max_u32 v10, v10, v11
    s_nop 0
    v_readfirstlane_b32 s39, v10
    s_nop 1
    s_add_u32 s40, s40, s39
    s_mov_b32 s67, s40
    s_and_b32 s41, s60, 0x7ff
    s_sub_u32 s70, 2047, s41
    s_and_b32 s41, s61, 0x7ff
    s_sub_u32 s71, 2047, s41
    s_and_b32 s41, s62, 0x7ff
    s_sub_u32 s72, 2047, s41
    s_and_b32 s41, s63, 0x7ff
    s_sub_u32 s73, 2047, s41
    s_and_b32 s41, s64, 0x7ff
    s_sub_u32 s74, 2047, s41
    s_and_b32 s41, s65, 0x7ff
    s_sub_u32 s75, 2047, s41
    s_and_b32 s41, s66, 0x7ff
    s_sub_u32 s76, 2047, s41
    s_and_b32 s41, s67, 0x7ff
    s_sub_u32 s77, 2047, s41
    v_mov_b32 v12, 0
    v_writelane_b32 v12, s70, 0
    v_writelane_b32 v12, s70, 32
    v_writelane_b32 v12, s71, 1
    v_writelane_b32 v12, s71, 33
    v_writelane_b32 v12, s72, 2
    v_writelane_b32 v12, s72, 34
    v_writelane_b32 v12, s73, 3
    v_writelane_b32 v12, s73, 35
    v_writelane_b32 v12, s74, 4
    v_writelane_b32 v12, s74, 36
    v_writelane_b32 v12, s75, 5
    v_writelane_b32 v12, s75, 37
    v_writelane_b32 v12, s76, 6
    v_writelane_b32 v12, s76, 38
    v_writelane_b32 v12, s77, 7
    v_writelane_b32 v12, s77, 39
    s_cmp_lg_u32 s2, 0
    s_cbranch_scc1 L_m1_nopub
    v_mov_b32 v13, 0
    s_and_b32 s41, s60, 0xffff0000
    s_xor_b32 s42, s41, 0x80000000
    s_not_b32 s43, s41
    s_and_b32 s43, s43, 0xffff0000
    s_cmp_ge_u32 s41, 0x80000000
    s_cselect_b32 s41, s42, s43
    v_writelane_b32 v13, s41, 0
    s_and_b32 s41, s61, 0xffff0000
    s_xor_b32 s42, s41, 0x80000000
    s_not_b32 s43, s41
    s_and_b32 s43, s43, 0xffff0000
    s_cmp_ge_u32 s41, 0x80000000
    s_cselect_b32 s41, s42, s43
    v_writelane_b32 v13, s41, 1
    s_and_b32 s41, s62, 0xffff0000
    s_xor_b32 s42, s41, 0x80000000
    s_not_b32 s43, s41
    s_and_b32 s43, s43, 0xffff0000
    s_cmp_ge_u32 s41, 0x80000000
    s_cselect_b32 s41, s42, s43
    v_writelane_b32 v13, s41, 2
    s_and_b32 s41, s63, 0xffff0000
    s_xor_b32 s42, s41, 0x80000000
    s_not_b32 s43, s41
    s_and_b32 s43, s43, 0xffff0000
    s_cmp_ge_u32 s41, 0x80000000
    s_cselect_b32 s41, s42, s43
    v_writelane_b32 v13, s41, 3
    s_and_b32 s41, s64, 0xffff0000
    s_xor_b32 s42, s41, 0x80000000
    s_not_b32 s43, s41
    s_and_b32 s43, s43, 0xffff0000
    s_cmp_ge_u32 s41, 0x80000000
    s_cselect_b32 s41, s42, s43
    v_writelane_b32 v13, s41, 4
    s_and_b32 s41, s65, 0xffff0000
    s_xor_b32 s42, s41, 0x80000000
    s_not_b32 s43, s41
    s_and_b32 s43, s43, 0xffff0000
    s_cmp_ge_u32 s41, 0x80000000
    s_cselect_b32 s41, s42, s43
    v_writelane_b32 v13, s41, 5
    s_and_b32 s41, s66, 0xffff0000
    s_xor_b32 s42, s41, 0x80000000
    s_not_b32 s43, s41
    s_and_b32 s43, s43, 0xffff0000
    s_cmp_ge_u32 s41, 0x80000000
    s_cselect_b32 s41, s42, s43
    v_writelane_b32 v13, s41, 6
    s_and_b32 s41, s67, 0xffff0000
    s_xor_b32 s42, s41, 0x80000000
    s_not_b32 s43, s41
    s_and_b32 s43, s43, 0xffff0000
    s_cmp_ge_u32 s41, 0x80000000
    s_cselect_b32 s41, s42, s43
    v_writelane_b32 v13, s41, 7
    v_mul_f32 v14, 0xbfb8aa3b, v13
    v_exp_f32 v14, v14
    s_nop 0
    v_add_f32 v14, 1.0, v14
    v_rcp_f32 v14, v14
    s_nop 0
    v_cvt_pk_bf16_f32 v14, 0, v14
    s_add_u32 s44, s4, 10747904
    s_addc_u32 s45, s5, 0
    s_and_b32 s45, s45, 0xffff
    s_mov_b32 s46, 64
    s_mov_b32 s47, 0x00020000
    v_lshlrev_b32 v15, 2, v2
    s_mov_b64 exec, 0xff
    buffer_store_dword v12, v15, s[44:47], 0 offen
    buffer_store_dword v14, v15, s[44:47], 0 offen offset:32
    s_mov_b64 exec, -1
L_m1_nopub:
    v_lshlrev_b32 v12, 10, v12
    v_lshrrev_b32 v13, 5, v2
    v_lshlrev_b32 v13, 4, v13
    v_add_u32 v12, v12, v13
    s_mov_b32 exec_lo, 0xff
    s_mov_b32 exec_hi, 0xff
    buffer_load_dwordx4 v[128:131], v12, s[24:27], 0 offen offset:0
    buffer_load_dwordx4 v[132:135], v12, s[24:27], 0 offen offset:32
    buffer_load_dwordx4 v[136:139], v12, s[24:27], 0 offen offset:64
    buffer_load_dwordx4 v[140:143], v12, s[24:27], 0 offen offset:96
    buffer_load_dwordx4 v[144:147], v12, s[24:27], 0 offen offset:128
    buffer_load_dwordx4 v[148:151], v12, s[24:27], 0 offen offset:160
    buffer_load_dwordx4 v[152:155], v12, s[24:27], 0 offen offset:192
    buffer_load_dwordx4 v[156:159], v12, s[24:27], 0 offen offset:224
    buffer_load_dwordx4 v[160:163], v12, s[24:27], 0 offen offset:256
    buffer_load_dwordx4 v[164:167], v12, s[24:27], 0 offen offset:288
    buffer_load_dwordx4 v[168:171], v12, s[24:27], 0 offen offset:320
    buffer_load_dwordx4 v[172:175], v12, s[24:27], 0 offen offset:352
    buffer_load_dwordx4 v[176:179], v12, s[24:27], 0 offen offset:384
    buffer_load_dwordx4 v[180:183], v12, s[24:27], 0 offen offset:416
    buffer_load_dwordx4 v[184:187], v12, s[24:27], 0 offen offset:448
    buffer_load_dwordx4 v[188:191], v12, s[24:27], 0 offen offset:480
    buffer_load_dwordx4 v[192:195], v12, s[24:27], 0 offen offset:512
    buffer_load_dwordx4 v[196:199], v12, s[24:27], 0 offen offset:544
    buffer_load_dwordx4 v[200:203], v12, s[24:27], 0 offen offset:576
    buffer_load_dwordx4 v[204:207], v12, s[24:27], 0 offen offset:608
    buffer_load_dwordx4 v[208:211], v12, s[24:27], 0 offen offset:640
    buffer_load_dwordx4 v[212:215], v12, s[24:27], 0 offen offset:672
    buffer_load_dwordx4 v[216:219], v12, s[24:27], 0 offen offset:704
    buffer_load_dwordx4 v[220:223], v12, s[24:27], 0 offen offset:736
    buffer_load_dwordx4 v[224:227], v12, s[24:27], 0 offen offset:768
    buffer_load_dwordx4 v[228:231], v12, s[24:27], 0 offen offset:800
    buffer_load_dwordx4 v[232:235], v12, s[24:27], 0 offen offset:832
    buffer_load_dwordx4 v[236:239], v12, s[24:27], 0 offen offset:864
    buffer_load_dwordx4 v[240:243], v12, s[24:27], 0 offen offset:896
    buffer_load_dwordx4 v[244:247], v12, s[24:27], 0 offen offset:928
    buffer_load_dwordx4 v[248:251], v12, s[24:27], 0 offen offset:960
    buffer_load_dwordx4 v[252:255], v12, s[24:27], 0 offen offset:992
    s_mov_b64 exec, -1
L_m1_stage:
    s_cmp_lg_u32 s35, 0
    s_cbranch_scc1 L_m1_w123
    s_waitcnt vmcnt(32)
    s_branch L_m1_wr
L_m1_w123:
    s_waitcnt vmcnt(0)
L_m1_wr:
    ds_write_b128 v7, v[64:67] offset:0
    ds_write_b128 v7, v[96:99] offset:32768
    ds_write_b128 v7, v[68:71] offset:4096
    ds_write_b128 v7, v[100:103] offset:36864
    ds_write_b128 v7, v[72:75] offset:8192
    ds_write_b128 v7, v[104:107] offset:40960
    ds_write_b128 v7, v[76:79] offset:12288
    ds_write_b128 v7, v[108:111] offset:45056
    ds_write_b128 v7, v[80:83] offset:16384
    ds_write_b128 v7, v[112:115] offset:49152
    ds_write_b128 v7, v[84:87] offset:20480
    ds_write_b128 v7, v[116:119] offset:53248
    ds_write_b128 v7, v[88:91] offset:24576
    ds_write_b128 v7, v[120:123] offset:57344
    ds_write_b128 v7, v[92:95] offset:28672
    ds_write_b128 v7, v[124:127] offset:61440
    s_waitcnt lgkmcnt(0)
    s_barrier
    s_cmp_lg_u32 s35, 0
    s_cbranch_scc1 L_k1_end
    v_and_b32 v14, 15, v2
    v_lshrrev_b32 v15, 2, v14
    v_and_b32 v14, 3, v14
    v_lshrrev_b32 v13, 5, v2
    v_lshlrev_b32 v13, 3, v13
    v_add_u32 v15, v15, v13
    v_lshlrev_b32 v15, 6, v15
    v_lshrrev_b32 v13, 4, v2
    v_and_b32 v13, 1, v13
    v_lshlrev_b32 v13, 5, v13
    v_lshlrev_b32 v14, 3, v14
    v_add_u32 v15, v15, v13
    v_add_u32 v15, v15, v14
    v_mov_b32 v32, 0
    v_mov_b32 v33, 0
    v_mov_b32 v34, 0
    v_mov_b32 v35, 0
    v_mov_b32 v36, 0
    v_mov_b32 v37, 0
    v_mov_b32 v38, 0
    v_mov_b32 v39, 0
    v_mov_b32 v40, 0
    v_mov_b32 v41, 0
    v_mov_b32 v42, 0
    v_mov_b32 v43, 0
    v_mov_b32 v44, 0
    v_mov_b32 v45, 0
    v_mov_b32 v46, 0
    v_mov_b32 v47, 0
    v_mov_b32 v48, 0
    v_mov_b32 v49, 0
    v_mov_b32 v50, 0
    v_mov_b32 v51, 0
    v_mov_b32 v52, 0
    v_mov_b32 v53, 0
    v_mov_b32 v54, 0
    v_mov_b32 v55, 0
    v_mov_b32 v56, 0
    v_mov_b32 v57, 0
    v_mov_b32 v58, 0
    v_mov_b32 v59, 0
    v_mov_b32 v60, 0
    v_mov_b32 v61, 0
    v_mov_b32 v62, 0
    v_mov_b32 v63, 0
    s_waitcnt vmcnt(0)
    ds_read_b64_tr_b16 v[16:17], v15 offset:0
    ds_read_b64_tr_b16 v[18:19], v15 offset:256
    ds_read_b64_tr_b16 v[20:21], v15 offset:32768
    ds_read_b64_tr_b16 v[22:23], v15 offset:33024
    ds_read_b64_tr_b16 v[24:25], v15 offset:1024
    ds_read_b64_tr_b16 v[26:27], v15 offset:1280
    ds_read_b64_tr_b16 v[28:29], v15 offset:33792
    ds_read_b64_tr_b16 v[30:31], v15 offset:34048
    s_waitcnt lgkmcnt(4)
    v_mfma_f32_32x32x16_bf16 v[32:47], v[16:19], v[128:131], v[32:47]
    v_mfma_f32_32x32x16_bf16 v[48:63], v[20:23], v[128:131], v[48:63]
    ds_read_b64_tr_b16 v[16:17], v15 offset:2048
    ds_read_b64_tr_b16 v[18:19], v15 offset:2304
    ds_read_b64_tr_b16 v[20:21], v15 offset:34816
    ds_read_b64_tr_b16 v[22:23], v15 offset:35072
    s_waitcnt lgkmcnt(4)
    v_mfma_f32_32x32x16_bf16 v[32:47], v[24:27], v[132:135], v[32:47]
    v_mfma_f32_32x32x16_bf16 v[48:63], v[28:31], v[132:135], v[48:63]
    ds_read_b64_tr_b16 v[24:25], v15 offset:3072
    ds_read_b64_tr_b16 v[26:27], v15 offset:3328
    ds_read_b64_tr_b16 v[28:29], v15 offset:35840
    ds_read_b64_tr_b16 v[30:31], v15 offset:36096
    s_waitcnt lgkmcnt(4)
    v_mfma_f32_32x32x16_bf16 v[32:47], v[16:19], v[136:139], v[32:47]
    v_mfma_f32_32x32x16_bf16 v[48:63], v[20:23], v[136:139], v[48:63]
    ds_read_b64_tr_b16 v[16:17], v15 offset:4096
    ds_read_b64_tr_b16 v[18:19], v15 offset:4352
    ds_read_b64_tr_b16 v[20:21], v15 offset:36864
    ds_read_b64_tr_b16 v[22:23], v15 offset:37120
    s_waitcnt lgkmcnt(4)
    v_mfma_f32_32x32x16_bf16 v[32:47], v[24:27], v[140:143], v[32:47]
    v_mfma_f32_32x32x16_bf16 v[48:63], v[28:31], v[140:143], v[48:63]
    ds_read_b64_tr_b16 v[24:25], v15 offset:5120
    ds_read_b64_tr_b16 v[26:27], v15 offset:5376
    ds_read_b64_tr_b16 v[28:29], v15 offset:37888
    ds_read_b64_tr_b16 v[30:31], v15 offset:38144
    s_waitcnt lgkmcnt(4)
    v_mfma_f32_32x32x16_bf16 v[32:47], v[16:19], v[144:147], v[32:47]
    v_mfma_f32_32x32x16_bf16 v[48:63], v[20:23], v[144:147], v[48:63]
    ds_read_b64_tr_b16 v[16:17], v15 offset:6144
    ds_read_b64_tr_b16 v[18:19], v15 offset:6400
    ds_read_b64_tr_b16 v[20:21], v15 offset:38912
    ds_read_b64_tr_b16 v[22:23], v15 offset:39168
    s_waitcnt lgkmcnt(4)
    v_mfma_f32_32x32x16_bf16 v[32:47], v[24:27], v[148:151], v[32:47]
    v_mfma_f32_32x32x16_bf16 v[48:63], v[28:31], v[148:151], v[48:63]
    ds_read_b64_tr_b16 v[24:25], v15 offset:7168
    ds_read_b64_tr_b16 v[26:27], v15 offset:7424
    ds_read_b64_tr_b16 v[28:29], v15 offset:39936
    ds_read_b64_tr_b16 v[30:31], v15 offset:40192
    s_waitcnt lgkmcnt(4)
    v_mfma_f32_32x32x16_bf16 v[32:47], v[16:19], v[152:155], v[32:47]
    v_mfma_f32_32x32x16_bf16 v[48:63], v[20:23], v[152:155], v[48:63]
    ds_read_b64_tr_b16 v[16:17], v15 offset:8192
    ds_read_b64_tr_b16 v[18:19], v15 offset:8448
    ds_read_b64_tr_b16 v[20:21], v15 offset:40960
    ds_read_b64_tr_b16 v[22:23], v15 offset:41216
    s_waitcnt lgkmcnt(4)
    v_mfma_f32_32x32x16_bf16 v[32:47], v[24:27], v[156:159], v[32:47]
    v_mfma_f32_32x32x16_bf16 v[48:63], v[28:31], v[156:159], v[48:63]
    ds_read_b64_tr_b16 v[24:25], v15 offset:9216
    ds_read_b64_tr_b16 v[26:27], v15 offset:9472
    ds_read_b64_tr_b16 v[28:29], v15 offset:41984
    ds_read_b64_tr_b16 v[30:31], v15 offset:42240
    s_waitcnt lgkmcnt(4)
    v_mfma_f32_32x32x16_bf16 v[32:47], v[16:19], v[160:163], v[32:47]
    v_mfma_f32_32x32x16_bf16 v[48:63], v[20:23], v[160:163], v[48:63]
    ds_read_b64_tr_b16 v[16:17], v15 offset:10240
    ds_read_b64_tr_b16 v[18:19], v15 offset:10496
    ds_read_b64_tr_b16 v[20:21], v15 offset:43008
    ds_read_b64_tr_b16 v[22:23], v15 offset:43264
    s_waitcnt lgkmcnt(4)
    v_mfma_f32_32x32x16_bf16 v[32:47], v[24:27], v[164:167], v[32:47]
    v_mfma_f32_32x32x16_bf16 v[48:63], v[28:31], v[164:167], v[48:63]
    ds_read_b64_tr_b16 v[24:25], v15 offset:11264
    ds_read_b64_tr_b16 v[26:27], v15 offset:11520
    ds_read_b64_tr_b16 v[28:29], v15 offset:44032
    ds_read_b64_tr_b16 v[30:31], v15 offset:44288
    s_waitcnt lgkmcnt(4)
    v_mfma_f32_32x32x16_bf16 v[32:47], v[16:19], v[168:171], v[32:47]
    v_mfma_f32_32x32x16_bf16 v[48:63], v[20:23], v[168:171], v[48:63]
    ds_read_b64_tr_b16 v[16:17], v15 offset:12288
    ds_read_b64_tr_b16 v[18:19], v15 offset:12544
    ds_read_b64_tr_b16 v[20:21], v15 offset:45056
    ds_read_b64_tr_b16 v[22:23], v15 offset:45312
    s_waitcnt lgkmcnt(4)
    v_mfma_f32_32x32x16_bf16 v[32:47], v[24:27], v[172:175], v[32:47]
    v_mfma_f32_32x32x16_bf16 v[48:63], v[28:31], v[172:175], v[48:63]
    ds_read_b64_tr_b16 v[24:25], v15 offset:13312
    ds_read_b64_tr_b16 v[26:27], v15 offset:13568
    ds_read_b64_tr_b16 v[28:29], v15 offset:46080
    ds_read_b64_tr_b16 v[30:31], v15 offset:46336
    s_waitcnt lgkmcnt(4)
    v_mfma_f32_32x32x16_bf16 v[32:47], v[16:19], v[176:179], v[32:47]
    v_mfma_f32_32x32x16_bf16 v[48:63], v[20:23], v[176:179], v[48:63]
    ds_read_b64_tr_b16 v[16:17], v15 offset:14336
    ds_read_b64_tr_b16 v[18:19], v15 offset:14592
    ds_read_b64_tr_b16 v[20:21], v15 offset:47104
    ds_read_b64_tr_b16 v[22:23], v15 offset:47360
    s_waitcnt lgkmcnt(4)
    v_mfma_f32_32x32x16_bf16 v[32:47], v[24:27], v[180:183], v[32:47]
    v_mfma_f32_32x32x16_bf16 v[48:63], v[28:31], v[180:183], v[48:63]
    ds_read_b64_tr_b16 v[24:25], v15 offset:15360
    ds_read_b64_tr_b16 v[26:27], v15 offset:15616
    ds_read_b64_tr_b16 v[28:29], v15 offset:48128
    ds_read_b64_tr_b16 v[30:31], v15 offset:48384
    s_waitcnt lgkmcnt(4)
    v_mfma_f32_32x32x16_bf16 v[32:47], v[16:19], v[184:187], v[32:47]
    v_mfma_f32_32x32x16_bf16 v[48:63], v[20:23], v[184:187], v[48:63]
    ds_read_b64_tr_b16 v[16:17], v15 offset:16384
    ds_read_b64_tr_b16 v[18:19], v15 offset:16640
    ds_read_b64_tr_b16 v[20:21], v15 offset:49152
    ds_read_b64_tr_b16 v[22:23], v15 offset:49408
    s_waitcnt lgkmcnt(4)
    v_mfma_f32_32x32x16_bf16 v[32:47], v[24:27], v[188:191], v[32:47]
    v_mfma_f32_32x32x16_bf16 v[48:63], v[28:31], v[188:191], v[48:63]
    ds_read_b64_tr_b16 v[24:25], v15 offset:17408
    ds_read_b64_tr_b16 v[26:27], v15 offset:17664
    ds_read_b64_tr_b16 v[28:29], v15 offset:50176
    ds_read_b64_tr_b16 v[30:31], v15 offset:50432
    s_waitcnt lgkmcnt(4)
    v_mfma_f32_32x32x16_bf16 v[32:47], v[16:19], v[192:195], v[32:47]
    v_mfma_f32_32x32x16_bf16 v[48:63], v[20:23], v[192:195], v[48:63]
    ds_read_b64_tr_b16 v[16:17], v15 offset:18432
    ds_read_b64_tr_b16 v[18:19], v15 offset:18688
    ds_read_b64_tr_b16 v[20:21], v15 offset:51200
    ds_read_b64_tr_b16 v[22:23], v15 offset:51456
    s_waitcnt lgkmcnt(4)
    v_mfma_f32_32x32x16_bf16 v[32:47], v[24:27], v[196:199], v[32:47]
    v_mfma_f32_32x32x16_bf16 v[48:63], v[28:31], v[196:199], v[48:63]
    ds_read_b64_tr_b16 v[24:25], v15 offset:19456
    ds_read_b64_tr_b16 v[26:27], v15 offset:19712
    ds_read_b64_tr_b16 v[28:29], v15 offset:52224
    ds_read_b64_tr_b16 v[30:31], v15 offset:52480
    s_waitcnt lgkmcnt(4)
    v_mfma_f32_32x32x16_bf16 v[32:47], v[16:19], v[200:203], v[32:47]
    v_mfma_f32_32x32x16_bf16 v[48:63], v[20:23], v[200:203], v[48:63]
    ds_read_b64_tr_b16 v[16:17], v15 offset:20480
    ds_read_b64_tr_b16 v[18:19], v15 offset:20736
    ds_read_b64_tr_b16 v[20:21], v15 offset:53248
    ds_read_b64_tr_b16 v[22:23], v15 offset:53504
    s_waitcnt lgkmcnt(4)
    v_mfma_f32_32x32x16_bf16 v[32:47], v[24:27], v[204:207], v[32:47]
    v_mfma_f32_32x32x16_bf16 v[48:63], v[28:31], v[204:207], v[48:63]
    ds_read_b64_tr_b16 v[24:25], v15 offset:21504
    ds_read_b64_tr_b16 v[26:27], v15 offset:21760
    ds_read_b64_tr_b16 v[28:29], v15 offset:54272
    ds_read_b64_tr_b16 v[30:31], v15 offset:54528
    s_waitcnt lgkmcnt(4)
    v_mfma_f32_32x32x16_bf16 v[32:47], v[16:19], v[208:211], v[32:47]
    v_mfma_f32_32x32x16_bf16 v[48:63], v[20:23], v[208:211], v[48:63]
    ds_read_b64_tr_b16 v[16:17], v15 offset:22528
    ds_read_b64_tr_b16 v[18:19], v15 offset:22784
    ds_read_b64_tr_b16 v[20:21], v15 offset:55296
    ds_read_b64_tr_b16 v[22:23], v15 offset:55552
    s_waitcnt lgkmcnt(4)
    v_mfma_f32_32x32x16_bf16 v[32:47], v[24:27], v[212:215], v[32:47]
    v_mfma_f32_32x32x16_bf16 v[48:63], v[28:31], v[212:215], v[48:63]
    ds_read_b64_tr_b16 v[24:25], v15 offset:23552
    ds_read_b64_tr_b16 v[26:27], v15 offset:23808
    ds_read_b64_tr_b16 v[28:29], v15 offset:56320
    ds_read_b64_tr_b16 v[30:31], v15 offset:56576
    s_waitcnt lgkmcnt(4)
    v_mfma_f32_32x32x16_bf16 v[32:47], v[16:19], v[216:219], v[32:47]
    v_mfma_f32_32x32x16_bf16 v[48:63], v[20:23], v[216:219], v[48:63]
    ds_read_b64_tr_b16 v[16:17], v15 offset:24576
    ds_read_b64_tr_b16 v[18:19], v15 offset:24832
    ds_read_b64_tr_b16 v[20:21], v15 offset:57344
    ds_read_b64_tr_b16 v[22:23], v15 offset:57600
    s_waitcnt lgkmcnt(4)
    v_mfma_f32_32x32x16_bf16 v[32:47], v[24:27], v[220:223], v[32:47]
    v_mfma_f32_32x32x16_bf16 v[48:63], v[28:31], v[220:223], v[48:63]
    ds_read_b64_tr_b16 v[24:25], v15 offset:25600
    ds_read_b64_tr_b16 v[26:27], v15 offset:25856
    ds_read_b64_tr_b16 v[28:29], v15 offset:58368
    ds_read_b64_tr_b16 v[30:31], v15 offset:58624
    s_waitcnt lgkmcnt(4)
    v_mfma_f32_32x32x16_bf16 v[32:47], v[16:19], v[224:227], v[32:47]
    v_mfma_f32_32x32x16_bf16 v[48:63], v[20:23], v[224:227], v[48:63]
    ds_read_b64_tr_b16 v[16:17], v15 offset:26624
    ds_read_b64_tr_b16 v[18:19], v15 offset:26880
    ds_read_b64_tr_b16 v[20:21], v15 offset:59392
    ds_read_b64_tr_b16 v[22:23], v15 offset:59648
    s_waitcnt lgkmcnt(4)
    v_mfma_f32_32x32x16_bf16 v[32:47], v[24:27], v[228:231], v[32:47]
    v_mfma_f32_32x32x16_bf16 v[48:63], v[28:31], v[228:231], v[48:63]
    ds_read_b64_tr_b16 v[24:25], v15 offset:27648
    ds_read_b64_tr_b16 v[26:27], v15 offset:27904
    ds_read_b64_tr_b16 v[28:29], v15 offset:60416
    ds_read_b64_tr_b16 v[30:31], v15 offset:60672
    s_waitcnt lgkmcnt(4)
    v_mfma_f32_32x32x16_bf16 v[32:47], v[16:19], v[232:235], v[32:47]
    v_mfma_f32_32x32x16_bf16 v[48:63], v[20:23], v[232:235], v[48:63]
    ds_read_b64_tr_b16 v[16:17], v15 offset:28672
    ds_read_b64_tr_b16 v[18:19], v15 offset:28928
    ds_read_b64_tr_b16 v[20:21], v15 offset:61440
    ds_read_b64_tr_b16 v[22:23], v15 offset:61696
    s_waitcnt lgkmcnt(4)
    v_mfma_f32_32x32x16_bf16 v[32:47], v[24:27], v[236:239], v[32:47]
    v_mfma_f32_32x32x16_bf16 v[48:63], v[28:31], v[236:239], v[48:63]
    ds_read_b64_tr_b16 v[24:25], v15 offset:29696
    ds_read_b64_tr_b16 v[26:27], v15 offset:29952
    ds_read_b64_tr_b16 v[28:29], v15 offset:62464
    ds_read_b64_tr_b16 v[30:31], v15 offset:62720
    s_waitcnt lgkmcnt(4)
    v_mfma_f32_32x32x16_bf16 v[32:47], v[16:19], v[240:243], v[32:47]
    v_mfma_f32_32x32x16_bf16 v[48:63], v[20:23], v[240:243], v[48:63]
    ds_read_b64_tr_b16 v[16:17], v15 offset:30720
    ds_read_b64_tr_b16 v[18:19], v15 offset:30976
    ds_read_b64_tr_b16 v[20:21], v15 offset:63488
    ds_read_b64_tr_b16 v[22:23], v15 offset:63744
    s_waitcnt lgkmcnt(4)
    v_mfma_f32_32x32x16_bf16 v[32:47], v[24:27], v[244:247], v[32:47]
    v_mfma_f32_32x32x16_bf16 v[48:63], v[28:31], v[244:247], v[48:63]
    ds_read_b64_tr_b16 v[24:25], v15 offset:31744
    ds_read_b64_tr_b16 v[26:27], v15 offset:32000
    ds_read_b64_tr_b16 v[28:29], v15 offset:64512
    ds_read_b64_tr_b16 v[30:31], v15 offset:64768
    s_waitcnt lgkmcnt(4)
    v_mfma_f32_32x32x16_bf16 v[32:47], v[16:19], v[248:251], v[32:47]
    v_mfma_f32_32x32x16_bf16 v[48:63], v[20:23], v[248:251], v[48:63]
    s_waitcnt lgkmcnt(0)
    v_mfma_f32_32x32x16_bf16 v[32:47], v[24:27], v[252:255], v[32:47]
    v_mfma_f32_32x32x16_bf16 v[48:63], v[28:31], v[252:255], v[48:63]
    s_nop 15
    s_nop 3
    v_cvt_pk_bf16_f32 v32, 0, v32
    v_mul_f32 v16, 0xbfb8aa3b, v32
    v_exp_f32 v16, v16
    s_nop 0
    v_add_f32 v16, 1.0, v16
    v_rcp_f32 v16, v16
    s_nop 0
    v_mul_f32 v32, v32, v16
    v_cvt_pk_bf16_f32 v32, 0, v32
    v_cvt_pk_bf16_f32 v48, 0, v48
    v_mul_f32 v32, v32, v48
    v_cvt_pk_bf16_f32 v33, 0, v33
    v_mul_f32 v16, 0xbfb8aa3b, v33
    v_exp_f32 v16, v16
    s_nop 0
    v_add_f32 v16, 1.0, v16
    v_rcp_f32 v16, v16
    s_nop 0
    v_mul_f32 v33, v33, v16
    v_cvt_pk_bf16_f32 v33, 0, v33
    v_cvt_pk_bf16_f32 v49, 0, v49
    v_mul_f32 v33, v33, v49
    v_cvt_pk_bf16_f32 v34, 0, v34
    v_mul_f32 v16, 0xbfb8aa3b, v34
    v_exp_f32 v16, v16
    s_nop 0
    v_add_f32 v16, 1.0, v16
    v_rcp_f32 v16, v16
    s_nop 0
    v_mul_f32 v34, v34, v16
    v_cvt_pk_bf16_f32 v34, 0, v34
    v_cvt_pk_bf16_f32 v50, 0, v50
    v_mul_f32 v34, v34, v50
    v_cvt_pk_bf16_f32 v35, 0, v35
    v_mul_f32 v16, 0xbfb8aa3b, v35
    v_exp_f32 v16, v16
    s_nop 0
    v_add_f32 v16, 1.0, v16
    v_rcp_f32 v16, v16
    s_nop 0
    v_mul_f32 v35, v35, v16
    v_cvt_pk_bf16_f32 v35, 0, v35
    v_cvt_pk_bf16_f32 v51, 0, v51
    v_mul_f32 v35, v35, v51
    v_cvt_pk_bf16_f32 v36, 0, v36
    v_mul_f32 v16, 0xbfb8aa3b, v36
    v_exp_f32 v16, v16
    s_nop 0
    v_add_f32 v16, 1.0, v16
    v_rcp_f32 v16, v16
    s_nop 0
    v_mul_f32 v36, v36, v16
    v_cvt_pk_bf16_f32 v36, 0, v36
    v_cvt_pk_bf16_f32 v52, 0, v52
    v_mul_f32 v36, v36, v52
    v_cvt_pk_bf16_f32 v37, 0, v37
    v_mul_f32 v16, 0xbfb8aa3b, v37
    v_exp_f32 v16, v16
    s_nop 0
    v_add_f32 v16, 1.0, v16
    v_rcp_f32 v16, v16
    s_nop 0
    v_mul_f32 v37, v37, v16
    v_cvt_pk_bf16_f32 v37, 0, v37
    v_cvt_pk_bf16_f32 v53, 0, v53
    v_mul_f32 v37, v37, v53
    v_cvt_pk_bf16_f32 v38, 0, v38
    v_mul_f32 v16, 0xbfb8aa3b, v38
    v_exp_f32 v16, v16
    s_nop 0
    v_add_f32 v16, 1.0, v16
    v_rcp_f32 v16, v16
    s_nop 0
    v_mul_f32 v38, v38, v16
    v_cvt_pk_bf16_f32 v38, 0, v38
    v_cvt_pk_bf16_f32 v54, 0, v54
    v_mul_f32 v38, v38, v54
    v_cvt_pk_bf16_f32 v39, 0, v39
    v_mul_f32 v16, 0xbfb8aa3b, v39
    v_exp_f32 v16, v16
    s_nop 0
    v_add_f32 v16, 1.0, v16
    v_rcp_f32 v16, v16
    s_nop 0
    v_mul_f32 v39, v39, v16
    v_cvt_pk_bf16_f32 v39, 0, v39
    v_cvt_pk_bf16_f32 v55, 0, v55
    v_mul_f32 v39, v39, v55
    v_cvt_pk_bf16_f32 v40, 0, v40
    v_mul_f32 v16, 0xbfb8aa3b, v40
    v_exp_f32 v16, v16
    s_nop 0
    v_add_f32 v16, 1.0, v16
    v_rcp_f32 v16, v16
    s_nop 0
    v_mul_f32 v40, v40, v16
    v_cvt_pk_bf16_f32 v40, 0, v40
    v_cvt_pk_bf16_f32 v56, 0, v56
    v_mul_f32 v40, v40, v56
    v_cvt_pk_bf16_f32 v41, 0, v41
    v_mul_f32 v16, 0xbfb8aa3b, v41
    v_exp_f32 v16, v16
    s_nop 0
    v_add_f32 v16, 1.0, v16
    v_rcp_f32 v16, v16
    s_nop 0
    v_mul_f32 v41, v41, v16
    v_cvt_pk_bf16_f32 v41, 0, v41
    v_cvt_pk_bf16_f32 v57, 0, v57
    v_mul_f32 v41, v41, v57
    v_cvt_pk_bf16_f32 v42, 0, v42
    v_mul_f32 v16, 0xbfb8aa3b, v42
    v_exp_f32 v16, v16
    s_nop 0
    v_add_f32 v16, 1.0, v16
    v_rcp_f32 v16, v16
    s_nop 0
    v_mul_f32 v42, v42, v16
    v_cvt_pk_bf16_f32 v42, 0, v42
    v_cvt_pk_bf16_f32 v58, 0, v58
    v_mul_f32 v42, v42, v58
    v_cvt_pk_bf16_f32 v43, 0, v43
    v_mul_f32 v16, 0xbfb8aa3b, v43
    v_exp_f32 v16, v16
    s_nop 0
    v_add_f32 v16, 1.0, v16
    v_rcp_f32 v16, v16
    s_nop 0
    v_mul_f32 v43, v43, v16
    v_cvt_pk_bf16_f32 v43, 0, v43
    v_cvt_pk_bf16_f32 v59, 0, v59
    v_mul_f32 v43, v43, v59
    v_cvt_pk_bf16_f32 v44, 0, v44
    v_mul_f32 v16, 0xbfb8aa3b, v44
    v_exp_f32 v16, v16
    s_nop 0
    v_add_f32 v16, 1.0, v16
    v_rcp_f32 v16, v16
    s_nop 0
    v_mul_f32 v44, v44, v16
    v_cvt_pk_bf16_f32 v44, 0, v44
    v_cvt_pk_bf16_f32 v60, 0, v60
    v_mul_f32 v44, v44, v60
    v_cvt_pk_bf16_f32 v45, 0, v45
    v_mul_f32 v16, 0xbfb8aa3b, v45
    v_exp_f32 v16, v16
    s_nop 0
    v_add_f32 v16, 1.0, v16
    v_rcp_f32 v16, v16
    s_nop 0
    v_mul_f32 v45, v45, v16
    v_cvt_pk_bf16_f32 v45, 0, v45
    v_cvt_pk_bf16_f32 v61, 0, v61
    v_mul_f32 v45, v45, v61
    v_cvt_pk_bf16_f32 v46, 0, v46
    v_mul_f32 v16, 0xbfb8aa3b, v46
    v_exp_f32 v16, v16
    s_nop 0
    v_add_f32 v16, 1.0, v16
    v_rcp_f32 v16, v16
    s_nop 0
    v_mul_f32 v46, v46, v16
    v_cvt_pk_bf16_f32 v46, 0, v46
    v_cvt_pk_bf16_f32 v62, 0, v62
    v_mul_f32 v46, v46, v62
    v_cvt_pk_bf16_f32 v47, 0, v47
    v_mul_f32 v16, 0xbfb8aa3b, v47
    v_exp_f32 v16, v16
    s_nop 0
    v_add_f32 v16, 1.0, v16
    v_rcp_f32 v16, v16
    s_nop 0
    v_mul_f32 v47, v47, v16
    v_cvt_pk_bf16_f32 v47, 0, v47
    v_cvt_pk_bf16_f32 v63, 0, v63
    v_mul_f32 v47, v47, v63
    v_cvt_pk_bf16_f32 v16, v32, v33
    v_cvt_pk_bf16_f32 v17, v34, v35
    v_cvt_pk_bf16_f32 v18, v36, v37
    v_cvt_pk_bf16_f32 v19, v38, v39
    v_cvt_pk_bf16_f32 v20, v40, v41
    v_cvt_pk_bf16_f32 v21, v42, v43
    v_cvt_pk_bf16_f32 v22, v44, v45
    v_cvt_pk_bf16_f32 v23, v46, v47
    v_lshlrev_b32 v3, 4, v2
    s_lshl_b32 s37, s2, 11
    buffer_store_dwordx4 v[16:19], v3, s[28:31], s37 offen
    buffer_store_dwordx4 v[20:23], v3, s[28:31], s37 offen offset:1024
L_k1_end:
    s_endpgm
.section .rodata,"a"
.p2align 6
.amdhsa_kernel qkv_kernel
    .amdhsa_next_free_vgpr 256
    .amdhsa_next_free_sgpr 102
    .amdhsa_accum_offset 256
    .amdhsa_group_segment_fixed_size 0
    .amdhsa_kernarg_size 88
    .amdhsa_user_sgpr_count 2
    .amdhsa_user_sgpr_kernarg_segment_ptr 1
    .amdhsa_system_sgpr_workgroup_id_x 1
.end_amdhsa_kernel
.text
.globl attn_kernel
.p2align 8
.type attn_kernel,@function
attn_kernel:
    s_cmp_ge_u32 s2, 528
    s_cbranch_scc1 L_k2_end
    s_cmp_lt_u32 s2, 16
    s_cbranch_scc1 L_k2_mod
    s_sub_u32 s33, s2, 16
    s_and_b32 s34, s33, 7
    s_lshr_b32 s33, s33, 3
    s_lshr_b32 s35, s33, 4
    s_lshl_b32 s35, s35, 3
    s_add_u32 s35, s35, s34
    s_and_b32 s36, s33, 15
    s_load_dwordx2 s[4:5], s[0:1], 80
    v_lshrrev_b32 v3, 6, v0
    s_nop 0
    v_readfirstlane_b32 s37, v3
    v_and_b32 v3, 63, v0
    v_and_b32 v1, 31, v3
    v_lshlrev_b32 v1, 5, v1
    v_lshrrev_b32 v91, 5, v3
    v_lshlrev_b32 v91, 4, v91
    v_add_u32 v1, v1, v91
    v_and_b32 v2, 15, v3
    v_lshlrev_b32 v2, 6, v2
    v_add_u32 v2, v2, v91
    s_lshl_b32 s38, s36, 2
    s_add_u32 s38, s38, s37
    s_lshl_b32 s39, s35, 16
    s_waitcnt lgkmcnt(0)
    s_add_u32 s12, s4, s39
    s_addc_u32 s13, s5, 0
    s_add_u32 s12, s12, 4194304
    s_addc_u32 s13, s13, 0
    s_and_b32 s13, s13, 0xffff
    s_mov_b32 s14, 65536
    s_mov_b32 s15, 0x00020000
    s_add_u32 s16, s4, s39
    s_addc_u32 s17, s5, 0
    s_add_u32 s16, s16, 6291456
    s_addc_u32 s17, s17, 0
    s_and_b32 s17, s17, 0xffff
    s_mov_b32 s18, 65536
    s_mov_b32 s19, 0x00020000
    s_add_u32 s20, s4, s39
    s_addc_u32 s21, s5, 0
    s_add_u32 s20, s20, 2097152
    s_addc_u32 s21, s21, 0
    s_and_b32 s21, s21, 0xffff
    s_mov_b32 s22, 65536
    s_mov_b32 s23, 0x00020000
    s_add_u32 s24, s4, s39
    s_addc_u32 s25, s5, 0
    s_add_u32 s24, s24, 8388608
    s_addc_u32 s25, s25, 0
    s_and_b32 s25, s25, 0xffff
    s_mov_b32 s26, 65536
    s_mov_b32 s27, 0x00020000
    s_mov_b32 s44, 0x3eb8aa3b
    s_mov_b32 s45, 0x3eb8aa3b
    s_mov_b32 s46, 0x0000ffff
    s_mov_b32 s47, 0x0000ffff
    s_lshl_b32 s42, s38, 10
    buffer_load_dwordx4 v[4:7], v1, s[20:23], s42 offen
    s_mov_b32 s48, 0
L_k2_start:
    v_mov_b32 v32, 0
    v_mov_b32 v33, 0
    v_mov_b32 v34, 0
    v_mov_b32 v35, 0
    v_mov_b32 v36, 0
    v_mov_b32 v37, 0
    v_mov_b32 v38, 0
    v_mov_b32 v39, 0
    v_mov_b32 v40, 0
    v_mov_b32 v41, 0
    v_mov_b32 v42, 0
    v_mov_b32 v43, 0
    v_mov_b32 v44, 0
    v_mov_b32 v45, 0
    v_mov_b32 v46, 0
    v_mov_b32 v47, 0
    v_mov_b32 v16, 0x3f803f80
    v_mov_b32 v17, 0x3f803f80
    v_mov_b32 v18, 0x3f803f80
    v_mov_b32 v19, 0x3f803f80
    v_mov_b32 v20, 0x3f803f80
    v_mov_b32 v21, 0x3f803f80
    v_mov_b32 v22, 0x3f803f80
    v_mov_b32 v23, 0x3f803f80
    v_mov_b32 v24, 0x3f803f80
    v_mov_b32 v25, 0x3f803f80
    v_mov_b32 v26, 0x3f803f80
    v_mov_b32 v27, 0x3f803f80
    v_mov_b32 v28, 0x3f803f80
    v_mov_b32 v29, 0x3f803f80
    v_mov_b32 v30, 0x3f803f80
    v_mov_b32 v31, 0x3f803f80
    v_mov_b32 v96, 0
    v_mov_b32 v97, 0
    v_mov_b32 v98, 0
    v_mov_b32 v99, 0
    v_mov_b32 v100, 0
    v_mov_b32 v101, 0
    v_mov_b32 v102, 0
    v_mov_b32 v103, 0
    buffer_load_dwordx4 v[8:11], v1, s[12:15], 0 offen
    buffer_load_dwordx4 v[12:15], v1, s[12:15], 0 offen offset:1024
    s_mov_b64 exec, s[46:47]
    buffer_load_dwordx4 v[24:27], v2, s[16:19], 0 offen
    buffer_load_dwordx4 v[28:31], v2, s[16:19], 0 offen offset:32
    s_mov_b64 exec, -1
    s_waitcnt vmcnt(3)
    v_mfma_f32_32x32x16_bf16 v[48:63], v[8:11], v[4:7], 0
    buffer_load_dwordx4 v[8:11], v1, s[12:15], 0 offen offset:2048
    s_mov_b64 exec, s[46:47]
    buffer_load_dwordx4 v[16:19], v2, s[16:19], 0 offen
    buffer_load_dwordx4 v[20:23], v2, s[16:19], 0 offen offset:32
    s_mov_b64 exec, -1
    s_mov_b32 s40, 3072
    s_mov_b32 s41, 1024
    s_mov_b32 s49, 0x33800000
    s_cmp_eq_u32 s48, 1
    s_cbranch_scc1 L_k2_loop0
    s_nop 15
    v_max3_f32 v89, v48, v49, v50
    v_max3_f32 v89, v89, v51, v52
    v_max3_f32 v89, v89, v53, v54
    v_max3_f32 v89, v89, v55, v56
    v_max3_f32 v89, v89, v57, v58
    v_max3_f32 v89, v89, v59, v60
    v_max3_f32 v89, v89, v61, v62
    v_max_f32 v89, v89, v63
    v_mov_b32 v90, v89
    s_nop 1
    v_permlane32_swap_b32 v89, v90
    v_max_f32 v89, v89, v90
    v_cvt_pk_bf16_f32 v89, 0, v89
    v_mul_f32 v88, 0xbeb8aa3b, v89
    v_add_f32 v88, 0xc2800000, v88
L_k2_loop0:
    s_mov_b32 s43, 0
L_k2_loop:
    v_cmp_lt_f32 vcc, s49, v40
    s_waitcnt vmcnt(5)
    v_mfma_f32_32x32x16_bf16 v[64:79], v[12:15], v[4:7], 0
    buffer_load_dwordx4 v[12:15], v1, s[12:15], s40 offen
    s_add_u32 s40, s40, 1024
    v_cvt_pk_bf16_f32 v48, 0, v48
    v_cvt_pk_bf16_f32 v49, 0, v49
    v_cvt_pk_bf16_f32 v50, 0, v50
    v_cvt_pk_bf16_f32 v51, 0, v51
    v_cvt_pk_bf16_f32 v52, 0, v52
    v_cvt_pk_bf16_f32 v53, 0, v53
    v_cvt_pk_bf16_f32 v54, 0, v54
    v_cvt_pk_bf16_f32 v55, 0, v55
    s_waitcnt vmcnt(4)
    v_mfma_f32_32x32x16_bf16 v[32:47], v[24:27], v[96:99], v[32:47]
    v_cvt_pk_bf16_f32 v56, 0, v56
    v_cvt_pk_bf16_f32 v57, 0, v57
    v_cvt_pk_bf16_f32 v58, 0, v58
    v_cvt_pk_bf16_f32 v59, 0, v59
    v_cvt_pk_bf16_f32 v60, 0, v60
    v_cvt_pk_bf16_f32 v61, 0, v61
    v_cvt_pk_bf16_f32 v62, 0, v62
    v_cvt_pk_bf16_f32 v63, 0, v63
    v_mfma_f32_32x32x16_bf16 v[32:47], v[28:31], v[100:103], v[32:47]
    s_mov_b64 exec, s[46:47]
    buffer_load_dwordx4 v[24:27], v2, s[16:19], s41 offen
    buffer_load_dwordx4 v[28:31], v2, s[16:19], s41 offen offset:32
    s_mov_b64 exec, -1
    s_add_u32 s41, s41, 1024
    s_cbranch_vccz L_k2_nors
    s_nop 15
    v_frexp_exp_i32_f32 v89, v40
    v_add_u32 v89, 64, v89
    v_sub_u32 v90, 0, v89
    v_ldexp_f32 v32, v32, v90
    v_ldexp_f32 v33, v33, v90
    v_ldexp_f32 v34, v34, v90
    v_ldexp_f32 v35, v35, v90
    v_ldexp_f32 v36, v36, v90
    v_ldexp_f32 v37, v37, v90
    v_ldexp_f32 v38, v38, v90
    v_ldexp_f32 v39, v39, v90
    v_ldexp_f32 v40, v40, v90
    v_cvt_f32_i32 v89, v89
    v_sub_f32 v88, v88, v89
    s_nop 1
L_k2_nors:
    v_pk_fma_f32 v[48:49], v[48:49], s[44:45], v[88:89] op_sel_hi:[1,0,0]
    v_pk_fma_f32 v[50:51], v[50:51], s[44:45], v[88:89] op_sel_hi:[1,0,0]
    v_pk_fma_f32 v[52:53], v[52:53], s[44:45], v[88:89] op_sel_hi:[1,0,0]
    v_pk_fma_f32 v[54:55], v[54:55], s[44:45], v[88:89] op_sel_hi:[1,0,0]
    v_pk_fma_f32 v[56:57], v[56:57], s[44:45], v[88:89] op_sel_hi:[1,0,0]
    v_pk_fma_f32 v[58:59], v[58:59], s[44:45], v[88:89] op_sel_hi:[1,0,0]
    v_pk_fma_f32 v[60:61], v[60:61], s[44:45], v[88:89] op_sel_hi:[1,0,0]
    v_pk_fma_f32 v[62:63], v[62:63], s[44:45], v[88:89] op_sel_hi:[1,0,0]
    v_exp_f32 v48, v48
    v_exp_f32 v49, v49
    v_exp_f32 v50, v50
    v_exp_f32 v51, v51
    v_exp_f32 v52, v52
    v_exp_f32 v53, v53
    v_exp_f32 v54, v54
    v_exp_f32 v55, v55
    v_exp_f32 v56, v56
    v_exp_f32 v57, v57
    v_exp_f32 v58, v58
    v_exp_f32 v59, v59
    v_exp_f32 v60, v60
    v_exp_f32 v61, v61
    v_exp_f32 v62, v62
    v_exp_f32 v63, v63
    v_cvt_pk_bf16_f32 v80, v48, v49
    v_cvt_pk_bf16_f32 v81, v50, v51
    v_cvt_pk_bf16_f32 v82, v52, v53
    v_cvt_pk_bf16_f32 v83, v54, v55
    v_cvt_pk_bf16_f32 v84, v56, v57
    v_cvt_pk_bf16_f32 v85, v58, v59
    v_cvt_pk_bf16_f32 v86, v60, v61
    v_cvt_pk_bf16_f32 v87, v62, v63
    s_waitcnt vmcnt(5)
    v_mfma_f32_32x32x16_bf16 v[48:63], v[8:11], v[4:7], 0
    buffer_load_dwordx4 v[8:11], v1, s[12:15], s40 offen
    s_add_u32 s40, s40, 1024
    v_cvt_pk_bf16_f32 v64, 0, v64
    v_cvt_pk_bf16_f32 v65, 0, v65
    v_cvt_pk_bf16_f32 v66, 0, v66
    v_cvt_pk_bf16_f32 v67, 0, v67
    v_cvt_pk_bf16_f32 v68, 0, v68
    v_cvt_pk_bf16_f32 v69, 0, v69
    v_cvt_pk_bf16_f32 v70, 0, v70
    v_cvt_pk_bf16_f32 v71, 0, v71
    s_waitcnt vmcnt(4)
    v_mfma_f32_32x32x16_bf16 v[32:47], v[16:19], v[80:83], v[32:47]
    v_cvt_pk_bf16_f32 v72, 0, v72
    v_cvt_pk_bf16_f32 v73, 0, v73
    v_cvt_pk_bf16_f32 v74, 0, v74
    v_cvt_pk_bf16_f32 v75, 0, v75
    v_cvt_pk_bf16_f32 v76, 0, v76
    v_cvt_pk_bf16_f32 v77, 0, v77
    v_cvt_pk_bf16_f32 v78, 0, v78
    v_cvt_pk_bf16_f32 v79, 0, v79
    v_mfma_f32_32x32x16_bf16 v[32:47], v[20:23], v[84:87], v[32:47]
    s_mov_b64 exec, s[46:47]
    buffer_load_dwordx4 v[16:19], v2, s[16:19], s41 offen
    buffer_load_dwordx4 v[20:23], v2, s[16:19], s41 offen offset:32
    s_mov_b64 exec, -1
    s_add_u32 s41, s41, 1024
    v_pk_fma_f32 v[64:65], v[64:65], s[44:45], v[88:89] op_sel_hi:[1,0,0]
    v_pk_fma_f32 v[66:67], v[66:67], s[44:45], v[88:89] op_sel_hi:[1,0,0]
    v_pk_fma_f32 v[68:69], v[68:69], s[44:45], v[88:89] op_sel_hi:[1,0,0]
    v_pk_fma_f32 v[70:71], v[70:71], s[44:45], v[88:89] op_sel_hi:[1,0,0]
    v_pk_fma_f32 v[72:73], v[72:73], s[44:45], v[88:89] op_sel_hi:[1,0,0]
    v_pk_fma_f32 v[74:75], v[74:75], s[44:45], v[88:89] op_sel_hi:[1,0,0]
    v_pk_fma_f32 v[76:77], v[76:77], s[44:45], v[88:89] op_sel_hi:[1,0,0]
    v_pk_fma_f32 v[78:79], v[78:79], s[44:45], v[88:89] op_sel_hi:[1,0,0]
    v_exp_f32 v64, v64
    v_exp_f32 v65, v65
    v_exp_f32 v66, v66
    v_exp_f32 v67, v67
    v_exp_f32 v68, v68
    v_exp_f32 v69, v69
    v_exp_f32 v70, v70
    v_exp_f32 v71, v71
    v_exp_f32 v72, v72
    v_exp_f32 v73, v73
    v_exp_f32 v74, v74
    v_exp_f32 v75, v75
    v_exp_f32 v76, v76
    v_exp_f32 v77, v77
    v_exp_f32 v78, v78
    v_exp_f32 v79, v79
    v_cvt_pk_bf16_f32 v96, v64, v65
    v_cvt_pk_bf16_f32 v97, v66, v67
    v_cvt_pk_bf16_f32 v98, v68, v69
    v_cvt_pk_bf16_f32 v99, v70, v71
    v_cvt_pk_bf16_f32 v100, v72, v73
    v_cvt_pk_bf16_f32 v101, v74, v75
    v_cvt_pk_bf16_f32 v102, v76, v77
    v_cvt_pk_bf16_f32 v103, v78, v79
    s_add_u32 s43, s43, 1
    s_cmp_lt_u32 s43, 32
    s_cbranch_scc1 L_k2_loop
    s_waitcnt vmcnt(0)
    v_mfma_f32_32x32x16_bf16 v[32:47], v[24:27], v[96:99], v[32:47]
    v_mfma_f32_32x32x16_bf16 v[32:47], v[28:31], v[100:103], v[32:47]
    s_nop 15
    v_add_f32 v89, abs(v32), abs(v33)
    v_add_f32 v89, v89, abs(v34)
    v_add_f32 v89, v89, abs(v35)
    v_add_f32 v89, v89, abs(v36)
    v_add_f32 v89, v89, abs(v37)
    v_add_f32 v89, v89, abs(v38)
    v_add_f32 v89, v89, abs(v39)
    v_add_f32 v89, v89, abs(v40)
    v_mov_b32 v90, 0x207
    v_cmp_class_f32 vcc, v89, v90
    s_cmp_eq_u32 s48, 1
    s_cbranch_scc1 L_k2_store
    s_cbranch_vccnz L_k2_exact
L_k2_store:
    v_rcp_f32 v89, v40
    s_nop 0
    v_mul_f32 v32, v32, v89
    v_mul_f32 v33, v33, v89
    v_mul_f32 v34, v34, v89
    v_mul_f32 v35, v35, v89
    v_mul_f32 v36, v36, v89
    v_mul_f32 v37, v37, v89
    v_mul_f32 v38, v38, v89
    v_mul_f32 v39, v39, v89
    v_cvt_pk_bf16_f32 v80, v32, v33
    v_cvt_pk_bf16_f32 v81, v34, v35
    v_cvt_pk_bf16_f32 v82, v36, v37
    v_cvt_pk_bf16_f32 v83, v38, v39
    buffer_store_dwordx4 v[80:83], v1, s[24:27], s42 offen
    s_branch L_k2_end
L_k2_exact:
    v_mov_b32 v89, 0xff800000
    s_mov_b32 s40, 0
L_k2_p1:
    buffer_load_dwordx4 v[8:11], v1, s[12:15], s40 offen
    s_waitcnt vmcnt(0)
    v_mfma_f32_32x32x16_bf16 v[48:63], v[8:11], v[4:7], 0
    s_nop 15
    v_max3_f32 v90, v48, v49, v50
    v_max3_f32 v90, v90, v51, v52
    v_max3_f32 v90, v90, v53, v54
    v_max3_f32 v90, v90, v55, v56
    v_max3_f32 v90, v90, v57, v58
    v_max3_f32 v90, v90, v59, v60
    v_max3_f32 v90, v90, v61, v62
    v_max_f32 v90, v90, v63
    v_max_f32 v89, v89, v90
    s_add_u32 s40, s40, 1024
    s_cmp_lt_u32 s40, 65536
    s_cbranch_scc1 L_k2_p1
    v_mov_b32 v90, v89
    s_nop 1
    v_permlane32_swap_b32 v89, v90
    v_max_f32 v89, v89, v90
    v_cvt_pk_bf16_f32 v89, 0, v89
    v_mul_f32 v88, 0xbeb8aa3b, v89
    v_add_f32 v88, 0xc2800000, v88
    s_mov_b32 s48, 1
    s_branch L_k2_start
L_k2_mod:
    v_lshrrev_b32 v1, 6, v0
    s_nop 0
    v_readfirstlane_b32 s35, v1
    s_cmp_lg_u32 s35, 0
    s_cbranch_scc1 L_k2_end
    s_load_dwordx2 s[4:5], s[0:1], 80
    s_load_dwordx2 s[6:7], s[0:1], 56
    v_and_b32 v2, 63, v0
    s_waitcnt lgkmcnt(0)
    s_mov_b32 s12, s6
    s_and_b32 s13, s7, 0xffff
    s_mov_b32 s14, 1409024
    s_mov_b32 s15, 0x00020000
    s_add_u32 s16, s4, 10551296
    s_addc_u32 s17, s5, 0
    s_and_b32 s17, s17, 0xffff
    s_mov_b32 s18, 88064
    s_mov_b32 s19, 0x00020000
    s_add_u32 s20, s4, 10747904
    s_addc_u32 s21, s5, 0
    s_and_b32 s21, s21, 0xffff
    s_mov_b32 s22, 64
    s_mov_b32 s23, 0x00020000
    s_add_u32 s24, s4, 10752000
    s_addc_u32 s25, s5, 0
    s_and_b32 s25, s25, 0xffff
    s_mov_b32 s26, 8192
    s_mov_b32 s27, 0x00020000
    v_and_b32 v3, 31, v2
    v_lshlrev_b32 v3, 1, v3
    v_lshrrev_b32 v4, 5, v2
    v_lshlrev_b32 v4, 12, v4
    v_add_u32 v3, v3, v4
    s_lshl_b32 s36, s2, 6
    v_add_u32 v3, s36, v3
    v_lshlrev_b32 v5, 4, v2
    v_mov_b32 v32, 0
    v_mov_b32 v33, 0
    v_mov_b32 v34, 0
    v_mov_b32 v35, 0
    v_mov_b32 v36, 0
    v_mov_b32 v37, 0
    v_mov_b32 v38, 0
    v_mov_b32 v39, 0
    v_mov_b32 v40, 0
    v_mov_b32 v41, 0
    v_mov_b32 v42, 0
    v_mov_b32 v43, 0
    v_mov_b32 v44, 0
    v_mov_b32 v45, 0
    v_mov_b32 v46, 0
    v_mov_b32 v47, 0
    s_mov_b32 s37, 0
    s_mov_b32 s38, 0
    buffer_load_ushort v64, v3, s[12:15], s37 offen offset:0
    buffer_load_ushort v65, v3, s[12:15], s37 offen offset:1024
    buffer_load_ushort v66, v3, s[12:15], s37 offen offset:2048
    buffer_load_ushort v67, v3, s[12:15], s37 offen offset:3072
    s_add_u32 s39, s37, 8192
    buffer_load_ushort v68, v3, s[12:15], s39 offen offset:0
    buffer_load_ushort v69, v3, s[12:15], s39 offen offset:1024
    buffer_load_ushort v70, v3, s[12:15], s39 offen offset:2048
    buffer_load_ushort v71, v3, s[12:15], s39 offen offset:3072
    buffer_load_dwordx4 v[72:75], v5, s[16:19], s38 offen
    s_add_u32 s37, s37, 16384
    s_add_u32 s38, s38, 1024
    buffer_load_ushort v76, v3, s[12:15], s37 offen offset:0
    buffer_load_ushort v77, v3, s[12:15], s37 offen offset:1024
    buffer_load_ushort v78, v3, s[12:15], s37 offen offset:2048
    buffer_load_ushort v79, v3, s[12:15], s37 offen offset:3072
    s_add_u32 s39, s37, 8192
    buffer_load_ushort v80, v3, s[12:15], s39 offen offset:0
    buffer_load_ushort v81, v3, s[12:15], s39 offen offset:1024
    buffer_load_ushort v82, v3, s[12:15], s39 offen offset:2048
    buffer_load_ushort v83, v3, s[12:15], s39 offen offset:3072
    buffer_load_dwordx4 v[84:87], v5, s[16:19], s38 offen
    s_add_u32 s37, s37, 16384
    s_add_u32 s38, s38, 1024
    s_mov_b32 s43, 0
L_m2_loop:
    buffer_load_ushort v88, v3, s[12:15], s37 offen offset:0
    buffer_load_ushort v89, v3, s[12:15], s37 offen offset:1024
    buffer_load_ushort v90, v3, s[12:15], s37 offen offset:2048
    buffer_load_ushort v91, v3, s[12:15], s37 offen offset:3072
    s_add_u32 s39, s37, 8192
    buffer_load_ushort v92, v3, s[12:15], s39 offen offset:0
    buffer_load_ushort v93, v3, s[12:15], s39 offen offset:1024
    buffer_load_ushort v94, v3, s[12:15], s39 offen offset:2048
    buffer_load_ushort v95, v3, s[12:15], s39 offen offset:3072
    buffer_load_dwordx4 v[96:99], v5, s[16:19], s38 offen
    s_add_u32 s37, s37, 16384
    s_add_u32 s38, s38, 1024
    buffer_load_ushort v100, v3, s[12:15], s37 offen offset:0
    buffer_load_ushort v101, v3, s[12:15], s37 offen offset:1024
    buffer_load_ushort v102, v3, s[12:15], s37 offen offset:2048
    buffer_load_ushort v103, v3, s[12:15], s37 offen offset:3072
    s_add_u32 s39, s37, 8192
    buffer_load_ushort v104, v3, s[12:15], s39 offen offset:0
    buffer_load_ushort v105, v3, s[12:15], s39 offen offset:1024
    buffer_load_ushort v106, v3, s[12:15], s39 offen offset:2048
    buffer_load_ushort v107, v3, s[12:15], s39 offen offset:3072
    buffer_load_dwordx4 v[108:111], v5, s[16:19], s38 offen
    s_add_u32 s37, s37, 16384
    s_add_u32 s38, s38, 1024
    s_waitcnt vmcnt(18)
    v_lshl_or_b32 v16, v65, 16, v64
    v_lshl_or_b32 v17, v67, 16, v66
    v_lshl_or_b32 v18, v69, 16, v68
    v_lshl_or_b32 v19, v71, 16, v70
    s_nop 1
    v_mfma_f32_32x32x16_bf16 v[32:47], v[16:19], v[72:75], v[32:47]
    v_lshl_or_b32 v16, v77, 16, v76
    v_lshl_or_b32 v17, v79, 16, v78
    v_lshl_or_b32 v18, v81, 16, v80
    v_lshl_or_b32 v19, v83, 16, v82
    s_nop 1
    v_mfma_f32_32x32x16_bf16 v[32:47], v[16:19], v[84:87], v[32:47]
    buffer_load_ushort v64, v3, s[12:15], s37 offen offset:0
    buffer_load_ushort v65, v3, s[12:15], s37 offen offset:1024
    buffer_load_ushort v66, v3, s[12:15], s37 offen offset:2048
    buffer_load_ushort v67, v3, s[12:15], s37 offen offset:3072
    s_add_u32 s39, s37, 8192
    buffer_load_ushort v68, v3, s[12:15], s39 offen offset:0
    buffer_load_ushort v69, v3, s[12:15], s39 offen offset:1024
    buffer_load_ushort v70, v3, s[12:15], s39 offen offset:2048
    buffer_load_ushort v71, v3, s[12:15], s39 offen offset:3072
    buffer_load_dwordx4 v[72:75], v5, s[16:19], s38 offen
    s_add_u32 s37, s37, 16384
    s_add_u32 s38, s38, 1024
    buffer_load_ushort v76, v3, s[12:15], s37 offen offset:0
    buffer_load_ushort v77, v3, s[12:15], s37 offen offset:1024
    buffer_load_ushort v78, v3, s[12:15], s37 offen offset:2048
    buffer_load_ushort v79, v3, s[12:15], s37 offen offset:3072
    s_add_u32 s39, s37, 8192
    buffer_load_ushort v80, v3, s[12:15], s39 offen offset:0
    buffer_load_ushort v81, v3, s[12:15], s39 offen offset:1024
    buffer_load_ushort v82, v3, s[12:15], s39 offen offset:2048
    buffer_load_ushort v83, v3, s[12:15], s39 offen offset:3072
    buffer_load_dwordx4 v[84:87], v5, s[16:19], s38 offen
    s_add_u32 s37, s37, 16384
    s_add_u32 s38, s38, 1024
    s_waitcnt vmcnt(18)
    v_lshl_or_b32 v16, v89, 16, v88
    v_lshl_or_b32 v17, v91, 16, v90
    v_lshl_or_b32 v18, v93, 16, v92
    v_lshl_or_b32 v19, v95, 16, v94
    s_nop 1
    v_mfma_f32_32x32x16_bf16 v[32:47], v[16:19], v[96:99], v[32:47]
    v_lshl_or_b32 v16, v101, 16, v100
    v_lshl_or_b32 v17, v103, 16, v102
    v_lshl_or_b32 v18, v105, 16, v104
    v_lshl_or_b32 v19, v107, 16, v106
    s_nop 1
    v_mfma_f32_32x32x16_bf16 v[32:47], v[16:19], v[108:111], v[32:47]
    s_add_u32 s43, s43, 1
    s_cmp_lt_u32 s43, 21
    s_cbranch_scc1 L_m2_loop
    s_waitcnt vmcnt(0)
    v_lshl_or_b32 v16, v65, 16, v64
    v_lshl_or_b32 v17, v67, 16, v66
    v_lshl_or_b32 v18, v69, 16, v68
    v_lshl_or_b32 v19, v71, 16, v70
    s_nop 1
    v_mfma_f32_32x32x16_bf16 v[32:47], v[16:19], v[72:75], v[32:47]
    v_lshl_or_b32 v16, v77, 16, v76
    v_lshl_or_b32 v17, v79, 16, v78
    v_lshl_or_b32 v18, v81, 16, v80
    v_lshl_or_b32 v19, v83, 16, v82
    s_nop 1
    v_mfma_f32_32x32x16_bf16 v[32:47], v[16:19], v[84:87], v[32:47]
    s_nop 15
    s_nop 3
    v_and_b32 v6, 31, v2
    v_lshlrev_b32 v6, 2, v6
    s_mov_b32 exec_lo, 0xff
    s_mov_b32 exec_hi, 0xff
    buffer_load_dword v7, v6, s[20:23], 0 offen offset:32
    s_waitcnt vmcnt(0)
    v_cvt_pk_bf16_f32 v32, 0, v32
    v_mul_f32 v32, v32, v7
    v_cvt_pk_bf16_f32 v33, 0, v33
    v_mul_f32 v33, v33, v7
    v_cvt_pk_bf16_f32 v34, 0, v34
    v_mul_f32 v34, v34, v7
    v_cvt_pk_bf16_f32 v35, 0, v35
    v_mul_f32 v35, v35, v7
    v_cvt_pk_bf16_f32 v36, 0, v36
    v_mul_f32 v36, v36, v7
    v_cvt_pk_bf16_f32 v37, 0, v37
    v_mul_f32 v37, v37, v7
    v_cvt_pk_bf16_f32 v38, 0, v38
    v_mul_f32 v38, v38, v7
    v_cvt_pk_bf16_f32 v39, 0, v39
    v_mul_f32 v39, v39, v7
    v_cvt_pk_bf16_f32 v40, 0, v40
    v_mul_f32 v40, v40, v7
    v_cvt_pk_bf16_f32 v41, 0, v41
    v_mul_f32 v41, v41, v7
    v_cvt_pk_bf16_f32 v42, 0, v42
    v_mul_f32 v42, v42, v7
    v_cvt_pk_bf16_f32 v43, 0, v43
    v_mul_f32 v43, v43, v7
    v_cvt_pk_bf16_f32 v44, 0, v44
    v_mul_f32 v44, v44, v7
    v_cvt_pk_bf16_f32 v45, 0, v45
    v_mul_f32 v45, v45, v7
    v_cvt_pk_bf16_f32 v46, 0, v46
    v_mul_f32 v46, v46, v7
    v_cvt_pk_bf16_f32 v47, 0, v47
    v_mul_f32 v47, v47, v7
    v_and_b32 v6, 31, v2
    v_lshlrev_b32 v6, 10, v6
    v_lshrrev_b32 v4, 5, v2
    v_lshlrev_b32 v4, 3, v4
    v_add_u32 v6, v6, v4
    v_add_u32 v6, s36, v6
    v_cvt_pk_bf16_f32 v48, v32, v33
    v_cvt_pk_bf16_f32 v49, v34, v35
    buffer_store_dwordx2 v[48:49], v6, s[24:27], 0 offen offset:0
    v_cvt_pk_bf16_f32 v50, v36, v37
    v_cvt_pk_bf16_f32 v51, v38, v39
    buffer_store_dwordx2 v[50:51], v6, s[24:27], 0 offen offset:16
    v_cvt_pk_bf16_f32 v52, v40, v41
    v_cvt_pk_bf16_f32 v53, v42, v43
    buffer_store_dwordx2 v[52:53], v6, s[24:27], 0 offen offset:32
    v_cvt_pk_bf16_f32 v54, v44, v45
    v_cvt_pk_bf16_f32 v55, v46, v47
    buffer_store_dwordx2 v[54:55], v6, s[24:27], 0 offen offset:48
    s_mov_b64 exec, -1
L_k2_end:
    s_endpgm
.section .rodata,"a"
.p2align 6
.amdhsa_kernel attn_kernel
    .amdhsa_next_free_vgpr 128
    .amdhsa_next_free_sgpr 102
    .amdhsa_accum_offset 128
    .amdhsa_group_segment_fixed_size 0
    .amdhsa_kernarg_size 88
    .amdhsa_user_sgpr_count 2
    .amdhsa_user_sgpr_kernarg_segment_ptr 1
    .amdhsa_system_sgpr_workgroup_id_x 1
.end_amdhsa_kernel
.text
.globl outproj_kernel
.p2align 8
.type outproj_kernel,@function
outproj_kernel:
    s_cmp_ge_u32 s2, 256
    s_cbranch_scc1 L_k3_end
    s_lshr_b32 s34, s2, 3
    s_and_b32 s34, s34, 7
    s_lshr_b32 s33, s2, 6
    s_lshl_b32 s33, s33, 3
    s_and_b32 s36, s2, 7
    s_or_b32 s33, s33, s36
    s_load_dwordx2 s[4:5], s[0:1], 80
    s_load_dwordx2 s[6:7], s[0:1], 16
    s_load_dwordx2 s[8:9], s[0:1], 0
    s_load_dwordx2 s[10:11], s[0:1], 64
    v_lshrrev_b32 v1, 6, v0
    s_nop 0
    v_readfirstlane_b32 s35, v1
    v_and_b32 v2, 63, v0
    s_and_b32 s38, s35, 1
    s_lshr_b32 s39, s35, 1
    v_and_b32 v9, 31, v2
    v_lshrrev_b32 v10, 5, v2
    s_waitcnt lgkmcnt(0)
    s_mov_b32 s12, s6
    s_and_b32 s13, s7, 0xffff
    s_mov_b32 s14, 524288
    s_mov_b32 s15, 0x00020000
    s_add_u32 s16, s4, 8388608
    s_addc_u32 s17, s5, 0
    s_and_b32 s17, s17, 0xffff
    s_mov_b32 s18, 2097152
    s_mov_b32 s19, 0x00020000
    s_mov_b32 s20, s8
    s_and_b32 s21, s9, 0xffff
    s_mov_b32 s22, 2097152
    s_mov_b32 s23, 0x00020000
    s_mov_b32 s24, s4
    s_and_b32 s25, s5, 0xffff
    s_mov_b32 s26, 2097152
    s_mov_b32 s27, 0x00020000
    s_mov_b32 s28, s10
    s_and_b32 s29, s11, 0xffff
    s_mov_b32 s30, 2097152
    s_mov_b32 s31, 0x00020000
    s_lshl_b32 s40, s33, 6
    s_lshl_b32 s41, s38, 5
    s_add_u32 s40, s40, s41
    v_add_u32 v3, s40, v9
    v_lshlrev_b32 v4, 5, v3
    v_lshlrev_b32 v5, 4, v10
    v_add_u32 v4, v4, v5
    s_mov_b32 s42, 0
    buffer_load_dwordx4 v[64:67], v4, s[16:19], s42 offen
    s_add_u32 s42, s42, 65536
    buffer_load_dwordx4 v[68:71], v4, s[16:19], s42 offen
    s_add_u32 s42, s42, 65536
    buffer_load_dwordx4 v[72:75], v4, s[16:19], s42 offen
    s_add_u32 s42, s42, 65536
    buffer_load_dwordx4 v[76:79], v4, s[16:19], s42 offen
    s_add_u32 s42, s42, 65536
    buffer_load_dwordx4 v[80:83], v4, s[16:19], s42 offen
    s_add_u32 s42, s42, 65536
    buffer_load_dwordx4 v[84:87], v4, s[16:19], s42 offen
    s_add_u32 s42, s42, 65536
    buffer_load_dwordx4 v[88:91], v4, s[16:19], s42 offen
    s_add_u32 s42, s42, 65536
    buffer_load_dwordx4 v[92:95], v4, s[16:19], s42 offen
    s_add_u32 s42, s42, 65536
    buffer_load_dwordx4 v[96:99], v4, s[16:19], s42 offen
    s_add_u32 s42, s42, 65536
    buffer_load_dwordx4 v[100:103], v4, s[16:19], s42 offen
    s_add_u32 s42, s42, 65536
    buffer_load_dwordx4 v[104:107], v4, s[16:19], s42 offen
    s_add_u32 s42, s42, 65536
    buffer_load_dwordx4 v[108:111], v4, s[16:19], s42 offen
    s_add_u32 s42, s42, 65536
    buffer_load_dwordx4 v[112:115], v4, s[16:19], s42 offen
    s_add_u32 s42, s42, 65536
    buffer_load_dwordx4 v[116:119], v4, s[16:19], s42 offen
    s_add_u32 s42, s42, 65536
    buffer_load_dwordx4 v[120:123], v4, s[16:19], s42 offen
    s_add_u32 s42, s42, 65536
    buffer_load_dwordx4 v[124:127], v4, s[16:19], s42 offen
    s_add_u32 s42, s42, 65536
    buffer_load_dwordx4 v[128:131], v4, s[16:19], s42 offen
    s_add_u32 s42, s42, 65536
    buffer_load_dwordx4 v[132:135], v4, s[16:19], s42 offen
    s_add_u32 s42, s42, 65536
    buffer_load_dwordx4 v[136:139], v4, s[16:19], s42 offen
    s_add_u32 s42, s42, 65536
    buffer_load_dwordx4 v[140:143], v4, s[16:19], s42 offen
    s_add_u32 s42, s42, 65536
    buffer_load_dwordx4 v[144:147], v4, s[16:19], s42 offen
    s_add_u32 s42, s42, 65536
    buffer_load_dwordx4 v[148:151], v4, s[16:19], s42 offen
    s_add_u32 s42, s42, 65536
    buffer_load_dwordx4 v[152:155], v4, s[16:19], s42 offen
    s_add_u32 s42, s42, 65536
    buffer_load_dwordx4 v[156:159], v4, s[16:19], s42 offen
    s_add_u32 s42, s42, 65536
    buffer_load_dwordx4 v[160:163], v4, s[16:19], s42 offen
    s_add_u32 s42, s42, 65536
    buffer_load_dwordx4 v[164:167], v4, s[16:19], s42 offen
    s_add_u32 s42, s42, 65536
    buffer_load_dwordx4 v[168:171], v4, s[16:19], s42 offen
    s_add_u32 s42, s42, 65536
    buffer_load_dwordx4 v[172:175], v4, s[16:19], s42 offen
    s_add_u32 s42, s42, 65536
    buffer_load_dwordx4 v[176:179], v4, s[16:19], s42 offen
    s_add_u32 s42, s42, 65536
    buffer_load_dwordx4 v[180:183], v4, s[16:19], s42 offen
    s_add_u32 s42, s42, 65536
    buffer_load_dwordx4 v[184:187], v4, s[16:19], s42 offen
    s_add_u32 s42, s42, 65536
    buffer_load_dwordx4 v[188:191], v4, s[16:19], s42 offen
    s_add_u32 s42, s42, 65536
    v_lshlrev_b32 v6, 10, v3
    v_lshlrev_b32 v5, 3, v10
    v_add_u32 v6, v6, v5
    s_lshl_b32 s42, s34, 7
    s_lshl_b32 s43, s39, 6
    s_add_u32 s42, s42, s43
    v_add_u32 v6, s42, v6
    buffer_load_dwordx2 v[48:49], v6, s[20:23], 0 offen offset:0
    buffer_load_dwordx2 v[56:57], v6, s[24:27], 0 offen offset:0
    buffer_load_dwordx2 v[50:51], v6, s[20:23], 0 offen offset:16
    buffer_load_dwordx2 v[58:59], v6, s[24:27], 0 offen offset:16
    buffer_load_dwordx2 v[52:53], v6, s[20:23], 0 offen offset:32
    buffer_load_dwordx2 v[60:61], v6, s[24:27], 0 offen offset:32
    buffer_load_dwordx2 v[54:55], v6, s[20:23], 0 offen offset:48
    buffer_load_dwordx2 v[62:63], v6, s[24:27], 0 offen offset:48
    v_and_b32 v7, 7, v0
    v_lshlrev_b32 v7, 4, v7
    v_lshrrev_b32 v8, 3, v0
    v_lshlrev_b32 v11, 10, v8
    v_add_u32 v11, v11, v7
    v_mul_u32_u24 v12, 192, v8
    v_add_u32 v12, v12, v7
    v_add_u32 v13, 49152, v12
    s_lshl_b32 s42, s34, 7
    buffer_load_dwordx4 v[192:195], v11, s[12:15], s42 offen
    s_add_u32 s42, s42, 32768
    buffer_load_dwordx4 v[196:199], v11, s[12:15], s42 offen
    s_add_u32 s42, s42, 32768
    buffer_load_dwordx4 v[200:203], v11, s[12:15], s42 offen
    s_add_u32 s42, s42, 32768
    buffer_load_dwordx4 v[204:207], v11, s[12:15], s42 offen
    s_add_u32 s42, s42, 32768
    buffer_load_dwordx4 v[208:211], v11, s[12:15], s42 offen
    s_add_u32 s42, s42, 32768
    buffer_load_dwordx4 v[212:215], v11, s[12:15], s42 offen
    s_add_u32 s42, s42, 32768
    buffer_load_dwordx4 v[216:219], v11, s[12:15], s42 offen
    s_add_u32 s42, s42, 32768
    buffer_load_dwordx4 v[220:223], v11, s[12:15], s42 offen
    s_add_u32 s42, s42, 32768
    buffer_load_dwordx4 v[224:227], v11, s[12:15], s42 offen
    s_add_u32 s42, s42, 32768
    buffer_load_dwordx4 v[228:231], v11, s[12:15], s42 offen
    s_add_u32 s42, s42, 32768
    buffer_load_dwordx4 v[232:235], v11, s[12:15], s42 offen
    s_add_u32 s42, s42, 32768
    buffer_load_dwordx4 v[236:239], v11, s[12:15], s42 offen
    s_add_u32 s42, s42, 32768
    buffer_load_dwordx4 v[240:243], v11, s[12:15], s42 offen
    s_add_u32 s42, s42, 32768
    buffer_load_dwordx4 v[244:247], v11, s[12:15], s42 offen
    s_add_u32 s42, s42, 32768
    buffer_load_dwordx4 v[248:251], v11, s[12:15], s42 offen
    s_add_u32 s42, s42, 32768
    buffer_load_dwordx4 v[252:255], v11, s[12:15], s42 offen
    s_add_u32 s42, s42, 32768
    v_mov_b32 v32, 0
    v_mov_b32 v33, 0
    v_mov_b32 v34, 0
    v_mov_b32 v35, 0
    v_mov_b32 v36, 0
    v_mov_b32 v37, 0
    v_mov_b32 v38, 0
    v_mov_b32 v39, 0
    v_mov_b32 v40, 0
    v_mov_b32 v41, 0
    v_mov_b32 v42, 0
    v_mov_b32 v43, 0
    v_mov_b32 v44, 0
    v_mov_b32 v45, 0
    v_mov_b32 v46, 0
    v_mov_b32 v47, 0
    v_and_b32 v14, 15, v2
    v_lshrrev_b32 v15, 2, v14
    v_and_b32 v14, 3, v14
    v_lshlrev_b32 v5, 2, v10
    v_add_u32 v15, v15, v5
    v_mul_u32_u24 v15, 192, v15
    v_lshrrev_b32 v5, 4, v2
    v_and_b32 v5, 1, v5
    v_lshlrev_b32 v5, 5, v5
    v_lshlrev_b32 v14, 3, v14
    v_add_u32 v15, v15, v5
    v_add_u32 v15, v15, v14
    s_lshl_b32 s43, s39, 6
    v_add_u32 v15, s43, v15
    v_add_u32 v14, 49152, v15
    s_waitcnt vmcnt(0)
    ds_write_b128 v12, v[192:195] offset:0
    ds_write_b128 v12, v[196:199] offset:6144
    ds_write_b128 v12, v[200:203] offset:12288
    ds_write_b128 v12, v[204:207] offset:18432
    ds_write_b128 v12, v[208:211] offset:24576
    ds_write_b128 v12, v[212:215] offset:30720
    ds_write_b128 v12, v[216:219] offset:36864
    ds_write_b128 v12, v[220:223] offset:43008
    ds_write_b128 v13, v[224:227] offset:0
    ds_write_b128 v13, v[228:231] offset:6144
    ds_write_b128 v13, v[232:235] offset:12288
    ds_write_b128 v13, v[236:239] offset:18432
    ds_write_b128 v13, v[240:243] offset:24576
    ds_write_b128 v13, v[244:247] offset:30720
    ds_write_b128 v13, v[248:251] offset:36864
    ds_write_b128 v13, v[252:255] offset:43008
    s_waitcnt lgkmcnt(0)
    s_barrier
    ds_read_b64_tr_b16 v[16:17], v15 offset:0
    ds_read_b64_tr_b16 v[18:19], v15 offset:1536
    ds_read_b64_tr_b16 v[20:21], v15 offset:3072
    ds_read_b64_tr_b16 v[22:23], v15 offset:4608
    s_waitcnt lgkmcnt(2)
    v_mfma_f32_32x32x16_bf16 v[32:47], v[16:19], v[64:67], v[32:47]
    ds_read_b64_tr_b16 v[16:17], v15 offset:6144
    ds_read_b64_tr_b16 v[18:19], v15 offset:7680
    s_waitcnt lgkmcnt(2)
    v_mfma_f32_32x32x16_bf16 v[32:47], v[20:23], v[68:71], v[32:47]
    ds_read_b64_tr_b16 v[20:21], v15 offset:9216
    ds_read_b64_tr_b16 v[22:23], v15 offset:10752
    s_waitcnt lgkmcnt(2)
    v_mfma_f32_32x32x16_bf16 v[32:47], v[16:19], v[72:75], v[32:47]
    ds_read_b64_tr_b16 v[16:17], v15 offset:12288
    ds_read_b64_tr_b16 v[18:19], v15 offset:13824
    s_waitcnt lgkmcnt(2)
    v_mfma_f32_32x32x16_bf16 v[32:47], v[20:23], v[76:79], v[32:47]
    ds_read_b64_tr_b16 v[20:21], v15 offset:15360
    ds_read_b64_tr_b16 v[22:23], v15 offset:16896
    s_waitcnt lgkmcnt(2)
    v_mfma_f32_32x32x16_bf16 v[32:47], v[16:19], v[80:83], v[32:47]
    ds_read_b64_tr_b16 v[16:17], v15 offset:18432
    ds_read_b64_tr_b16 v[18:19], v15 offset:19968
    s_waitcnt lgkmcnt(2)
    v_mfma_f32_32x32x16_bf16 v[32:47], v[20:23], v[84:87], v[32:47]
    ds_read_b64_tr_b16 v[20:21], v15 offset:21504
    ds_read_b64_tr_b16 v[22:23], v15 offset:23040
    s_waitcnt lgkmcnt(2)
    v_mfma_f32_32x32x16_bf16 v[32:47], v[16:19], v[88:91], v[32:47]
    ds_read_b64_tr_b16 v[16:17], v15 offset:24576
    ds_read_b64_tr_b16 v[18:19], v15 offset:26112
    s_waitcnt lgkmcnt(2)
    v_mfma_f32_32x32x16_bf16 v[32:47], v[20:23], v[92:95], v[32:47]
    ds_read_b64_tr_b16 v[20:21], v15 offset:27648
    ds_read_b64_tr_b16 v[22:23], v15 offset:29184
    s_waitcnt lgkmcnt(2)
    v_mfma_f32_32x32x16_bf16 v[32:47], v[16:19], v[96:99], v[32:47]
    ds_read_b64_tr_b16 v[16:17], v15 offset:30720
    ds_read_b64_tr_b16 v[18:19], v15 offset:32256
    s_waitcnt lgkmcnt(2)
    v_mfma_f32_32x32x16_bf16 v[32:47], v[20:23], v[100:103], v[32:47]
    ds_read_b64_tr_b16 v[20:21], v15 offset:33792
    ds_read_b64_tr_b16 v[22:23], v15 offset:35328
    s_waitcnt lgkmcnt(2)
    v_mfma_f32_32x32x16_bf16 v[32:47], v[16:19], v[104:107], v[32:47]
    ds_read_b64_tr_b16 v[16:17], v15 offset:36864
    ds_read_b64_tr_b16 v[18:19], v15 offset:38400
    s_waitcnt lgkmcnt(2)
    v_mfma_f32_32x32x16_bf16 v[32:47], v[20:23], v[108:111], v[32:47]
    ds_read_b64_tr_b16 v[20:21], v15 offset:39936
    ds_read_b64_tr_b16 v[22:23], v15 offset:41472
    s_waitcnt lgkmcnt(2)
    v_mfma_f32_32x32x16_bf16 v[32:47], v[16:19], v[112:115], v[32:47]
    ds_read_b64_tr_b16 v[16:17], v15 offset:43008
    ds_read_b64_tr_b16 v[18:19], v15 offset:44544
    s_waitcnt lgkmcnt(2)
    v_mfma_f32_32x32x16_bf16 v[32:47], v[20:23], v[116:119], v[32:47]
    ds_read_b64_tr_b16 v[20:21], v15 offset:46080
    ds_read_b64_tr_b16 v[22:23], v15 offset:47616
    s_waitcnt lgkmcnt(2)
    v_mfma_f32_32x32x16_bf16 v[32:47], v[16:19], v[120:123], v[32:47]
    ds_read_b64_tr_b16 v[16:17], v14 offset:0
    ds_read_b64_tr_b16 v[18:19], v14 offset:1536
    s_waitcnt lgkmcnt(2)
    v_mfma_f32_32x32x16_bf16 v[32:47], v[20:23], v[124:127], v[32:47]
    ds_read_b64_tr_b16 v[20:21], v14 offset:3072
    ds_read_b64_tr_b16 v[22:23], v14 offset:4608
    s_waitcnt lgkmcnt(2)
    v_mfma_f32_32x32x16_bf16 v[32:47], v[16:19], v[128:131], v[32:47]
    ds_read_b64_tr_b16 v[16:17], v14 offset:6144
    ds_read_b64_tr_b16 v[18:19], v14 offset:7680
    s_waitcnt lgkmcnt(2)
    v_mfma_f32_32x32x16_bf16 v[32:47], v[20:23], v[132:135], v[32:47]
    ds_read_b64_tr_b16 v[20:21], v14 offset:9216
    ds_read_b64_tr_b16 v[22:23], v14 offset:10752
    s_waitcnt lgkmcnt(2)
    v_mfma_f32_32x32x16_bf16 v[32:47], v[16:19], v[136:139], v[32:47]
    ds_read_b64_tr_b16 v[16:17], v14 offset:12288
    ds_read_b64_tr_b16 v[18:19], v14 offset:13824
    s_waitcnt lgkmcnt(2)
    v_mfma_f32_32x32x16_bf16 v[32:47], v[20:23], v[140:143], v[32:47]
    ds_read_b64_tr_b16 v[20:21], v14 offset:15360
    ds_read_b64_tr_b16 v[22:23], v14 offset:16896
    s_waitcnt lgkmcnt(2)
    v_mfma_f32_32x32x16_bf16 v[32:47], v[16:19], v[144:147], v[32:47]
    ds_read_b64_tr_b16 v[16:17], v14 offset:18432
    ds_read_b64_tr_b16 v[18:19], v14 offset:19968
    s_waitcnt lgkmcnt(2)
    v_mfma_f32_32x32x16_bf16 v[32:47], v[20:23], v[148:151], v[32:47]
    ds_read_b64_tr_b16 v[20:21], v14 offset:21504
    ds_read_b64_tr_b16 v[22:23], v14 offset:23040
    s_waitcnt lgkmcnt(2)
    v_mfma_f32_32x32x16_bf16 v[32:47], v[16:19], v[152:155], v[32:47]
    ds_read_b64_tr_b16 v[16:17], v14 offset:24576
    ds_read_b64_tr_b16 v[18:19], v14 offset:26112
    s_waitcnt lgkmcnt(2)
    v_mfma_f32_32x32x16_bf16 v[32:47], v[20:23], v[156:159], v[32:47]
    ds_read_b64_tr_b16 v[20:21], v14 offset:27648
    ds_read_b64_tr_b16 v[22:23], v14 offset:29184
    s_waitcnt lgkmcnt(2)
    v_mfma_f32_32x32x16_bf16 v[32:47], v[16:19], v[160:163], v[32:47]
    ds_read_b64_tr_b16 v[16:17], v14 offset:30720
    ds_read_b64_tr_b16 v[18:19], v14 offset:32256
    s_waitcnt lgkmcnt(2)
    v_mfma_f32_32x32x16_bf16 v[32:47], v[20:23], v[164:167], v[32:47]
    ds_read_b64_tr_b16 v[20:21], v14 offset:33792
    ds_read_b64_tr_b16 v[22:23], v14 offset:35328
    s_waitcnt lgkmcnt(2)
    v_mfma_f32_32x32x16_bf16 v[32:47], v[16:19], v[168:171], v[32:47]
    ds_read_b64_tr_b16 v[16:17], v14 offset:36864
    ds_read_b64_tr_b16 v[18:19], v14 offset:38400
    s_waitcnt lgkmcnt(2)
    v_mfma_f32_32x32x16_bf16 v[32:47], v[20:23], v[172:175], v[32:47]
    ds_read_b64_tr_b16 v[20:21], v14 offset:39936
    ds_read_b64_tr_b16 v[22:23], v14 offset:41472
    s_waitcnt lgkmcnt(2)
    v_mfma_f32_32x32x16_bf16 v[32:47], v[16:19], v[176:179], v[32:47]
    ds_read_b64_tr_b16 v[16:17], v14 offset:43008
    ds_read_b64_tr_b16 v[18:19], v14 offset:44544
    s_waitcnt lgkmcnt(2)
    v_mfma_f32_32x32x16_bf16 v[32:47], v[20:23], v[180:183], v[32:47]
    ds_read_b64_tr_b16 v[20:21], v14 offset:46080
    ds_read_b64_tr_b16 v[22:23], v14 offset:47616
    s_waitcnt lgkmcnt(2)
    v_mfma_f32_32x32x16_bf16 v[32:47], v[16:19], v[184:187], v[32:47]
    s_waitcnt lgkmcnt(0)
    v_mfma_f32_32x32x16_bf16 v[32:47], v[20:23], v[188:191], v[32:47]
    s_add_u32 s36, s4, 10747904
    s_addc_u32 s37, s5, 0
    s_load_dwordx8 s[48:55], s[36:37], 0
    v_mov_b32 v16, -1
    s_waitcnt lgkmcnt(0)
    v_cmp_eq_u32 vcc, s48, v3
    s_nop 1
    v_cndmask_b32 v16, v16, 0, vcc
    v_cmp_eq_u32 vcc, s49, v3
    s_nop 1
    v_cndmask_b32 v16, v16, 1, vcc
    v_cmp_eq_u32 vcc, s50, v3
    s_nop 1
    v_cndmask_b32 v16, v16, 2, vcc
    v_cmp_eq_u32 vcc, s51, v3
    s_nop 1
    v_cndmask_b32 v16, v16, 3, vcc
    v_cmp_eq_u32 vcc, s52, v3
    s_nop 1
    v_cndmask_b32 v16, v16, 4, vcc
    v_cmp_eq_u32 vcc, s53, v3
    s_nop 1
    v_cndmask_b32 v16, v16, 5, vcc
    v_cmp_eq_u32 vcc, s54, v3
    s_nop 1
    v_cndmask_b32 v16, v16, 6, vcc
    v_cmp_eq_u32 vcc, s55, v3
    s_nop 1
    v_cndmask_b32 v16, v16, 7, vcc
    s_nop 15
    v_cvt_pk_bf16_f32 v32, 0, v32
    v_cvt_pk_bf16_f32 v33, 0, v33
    v_cvt_pk_bf16_f32 v34, 0, v34
    v_cvt_pk_bf16_f32 v35, 0, v35
    v_cvt_pk_bf16_f32 v36, 0, v36
    v_cvt_pk_bf16_f32 v37, 0, v37
    v_cvt_pk_bf16_f32 v38, 0, v38
    v_cvt_pk_bf16_f32 v39, 0, v39
    v_cvt_pk_bf16_f32 v40, 0, v40
    v_cvt_pk_bf16_f32 v41, 0, v41
    v_cvt_pk_bf16_f32 v42, 0, v42
    v_cvt_pk_bf16_f32 v43, 0, v43
    v_cvt_pk_bf16_f32 v44, 0, v44
    v_cvt_pk_bf16_f32 v45, 0, v45
    v_cvt_pk_bf16_f32 v46, 0, v46
    v_cvt_pk_bf16_f32 v47, 0, v47
    v_lshlrev_b32 v64, 16, v48
    v_and_b32 v65, 0xffff0000, v48
    v_lshlrev_b32 v80, 16, v56
    v_and_b32 v81, 0xffff0000, v56
    v_lshlrev_b32 v66, 16, v49
    v_and_b32 v67, 0xffff0000, v49
    v_lshlrev_b32 v82, 16, v57
    v_and_b32 v83, 0xffff0000, v57
    v_lshlrev_b32 v68, 16, v50
    v_and_b32 v69, 0xffff0000, v50
    v_lshlrev_b32 v84, 16, v58
    v_and_b32 v85, 0xffff0000, v58
    v_lshlrev_b32 v70, 16, v51
    v_and_b32 v71, 0xffff0000, v51
    v_lshlrev_b32 v86, 16, v59
    v_and_b32 v87, 0xffff0000, v59
    v_lshlrev_b32 v72, 16, v52
    v_and_b32 v73, 0xffff0000, v52
    v_lshlrev_b32 v88, 16, v60
    v_and_b32 v89, 0xffff0000, v60
    v_lshlrev_b32 v74, 16, v53
    v_and_b32 v75, 0xffff0000, v53
    v_lshlrev_b32 v90, 16, v61
    v_and_b32 v91, 0xffff0000, v61
    v_lshlrev_b32 v76, 16, v54
    v_and_b32 v77, 0xffff0000, v54
    v_lshlrev_b32 v92, 16, v62
    v_and_b32 v93, 0xffff0000, v62
    v_lshlrev_b32 v78, 16, v55
    v_and_b32 v79, 0xffff0000, v55
    v_lshlrev_b32 v94, 16, v63
    v_and_b32 v95, 0xffff0000, v63
    v_add_f32 v32, v64, v32
    v_cvt_pk_bf16_f32 v32, 0, v32
    v_add_f32 v33, v65, v33
    v_cvt_pk_bf16_f32 v33, 0, v33
    v_add_f32 v34, v66, v34
    v_cvt_pk_bf16_f32 v34, 0, v34
    v_add_f32 v35, v67, v35
    v_cvt_pk_bf16_f32 v35, 0, v35
    v_add_f32 v36, v68, v36
    v_cvt_pk_bf16_f32 v36, 0, v36
    v_add_f32 v37, v69, v37
    v_cvt_pk_bf16_f32 v37, 0, v37
    v_add_f32 v38, v70, v38
    v_cvt_pk_bf16_f32 v38, 0, v38
    v_add_f32 v39, v71, v39
    v_cvt_pk_bf16_f32 v39, 0, v39
    v_add_f32 v40, v72, v40
    v_cvt_pk_bf16_f32 v40, 0, v40
    v_add_f32 v41, v73, v41
    v_cvt_pk_bf16_f32 v41, 0, v41
    v_add_f32 v42, v74, v42
    v_cvt_pk_bf16_f32 v42, 0, v42
    v_add_f32 v43, v75, v43
    v_cvt_pk_bf16_f32 v43, 0, v43
    v_add_f32 v44, v76, v44
    v_cvt_pk_bf16_f32 v44, 0, v44
    v_add_f32 v45, v77, v45
    v_cvt_pk_bf16_f32 v45, 0, v45
    v_add_f32 v46, v78, v46
    v_cvt_pk_bf16_f32 v46, 0, v46
    v_add_f32 v47, v79, v47
    v_cvt_pk_bf16_f32 v47, 0, v47
    v_cmp_le_i32 vcc, 0, v16
    s_cbranch_vccz L_k3_nosel
    s_add_u32 s56, s4, 10752000
    s_addc_u32 s57, s5, 0
    s_and_b32 s57, s57, 0xffff
    s_mov_b32 s58, 8192
    s_mov_b32 s59, 0x00020000
    v_lshlrev_b32 v17, 10, v16
    v_lshlrev_b32 v5, 3, v10
    v_add_u32 v17, v17, v5
    s_lshl_b32 s42, s34, 7
    s_lshl_b32 s43, s39, 6
    s_add_u32 s42, s42, s43
    v_add_u32 v17, s42, v17
    s_and_saveexec_b64 s[60:61], vcc
    buffer_load_dwordx2 v[48:49], v17, s[56:59], 0 offen offset:0
    buffer_load_dwordx2 v[50:51], v17, s[56:59], 0 offen offset:16
    buffer_load_dwordx2 v[52:53], v17, s[56:59], 0 offen offset:32
    buffer_load_dwordx2 v[54:55], v17, s[56:59], 0 offen offset:48
    s_waitcnt vmcnt(0)
    v_lshlrev_b32 v18, 16, v48
    v_and_b32 v19, 0xffff0000, v48
    v_add_f32 v80, v80, v18
    v_add_f32 v81, v81, v19
    v_cvt_pk_bf16_f32 v80, 0, v80
    v_cvt_pk_bf16_f32 v81, 0, v81
    v_lshlrev_b32 v18, 16, v49
    v_and_b32 v19, 0xffff0000, v49
    v_add_f32 v82, v82, v18
    v_add_f32 v83, v83, v19
    v_cvt_pk_bf16_f32 v82, 0, v82
    v_cvt_pk_bf16_f32 v83, 0, v83
    v_lshlrev_b32 v18, 16, v50
    v_and_b32 v19, 0xffff0000, v50
    v_add_f32 v84, v84, v18
    v_add_f32 v85, v85, v19
    v_cvt_pk_bf16_f32 v84, 0, v84
    v_cvt_pk_bf16_f32 v85, 0, v85
    v_lshlrev_b32 v18, 16, v51
    v_and_b32 v19, 0xffff0000, v51
    v_add_f32 v86, v86, v18
    v_add_f32 v87, v87, v19
    v_cvt_pk_bf16_f32 v86, 0, v86
    v_cvt_pk_bf16_f32 v87, 0, v87
    v_lshlrev_b32 v18, 16, v52
    v_and_b32 v19, 0xffff0000, v52
    v_add_f32 v88, v88, v18
    v_add_f32 v89, v89, v19
    v_cvt_pk_bf16_f32 v88, 0, v88
    v_cvt_pk_bf16_f32 v89, 0, v89
    v_lshlrev_b32 v18, 16, v53
    v_and_b32 v19, 0xffff0000, v53
    v_add_f32 v90, v90, v18
    v_add_f32 v91, v91, v19
    v_cvt_pk_bf16_f32 v90, 0, v90
    v_cvt_pk_bf16_f32 v91, 0, v91
    v_lshlrev_b32 v18, 16, v54
    v_and_b32 v19, 0xffff0000, v54
    v_add_f32 v92, v92, v18
    v_add_f32 v93, v93, v19
    v_cvt_pk_bf16_f32 v92, 0, v92
    v_cvt_pk_bf16_f32 v93, 0, v93
    v_lshlrev_b32 v18, 16, v55
    v_and_b32 v19, 0xffff0000, v55
    v_add_f32 v94, v94, v18
    v_add_f32 v95, v95, v19
    v_cvt_pk_bf16_f32 v94, 0, v94
    v_cvt_pk_bf16_f32 v95, 0, v95
    s_mov_b64 exec, s[60:61]
L_k3_nosel:
    v_add_f32 v32, v32, v80
    v_add_f32 v33, v33, v81
    v_add_f32 v34, v34, v82
    v_add_f32 v35, v35, v83
    v_add_f32 v36, v36, v84
    v_add_f32 v37, v37, v85
    v_add_f32 v38, v38, v86
    v_add_f32 v39, v39, v87
    v_add_f32 v40, v40, v88
    v_add_f32 v41, v41, v89
    v_add_f32 v42, v42, v90
    v_add_f32 v43, v43, v91
    v_add_f32 v44, v44, v92
    v_add_f32 v45, v45, v93
    v_add_f32 v46, v46, v94
    v_add_f32 v47, v47, v95
    v_cvt_pk_bf16_f32 v48, v32, v33
    v_cvt_pk_bf16_f32 v49, v34, v35
    buffer_store_dwordx2 v[48:49], v6, s[28:31], 0 offen offset:0
    v_cvt_pk_bf16_f32 v50, v36, v37
    v_cvt_pk_bf16_f32 v51, v38, v39
    buffer_store_dwordx2 v[50:51], v6, s[28:31], 0 offen offset:16
    v_cvt_pk_bf16_f32 v52, v40, v41
    v_cvt_pk_bf16_f32 v53, v42, v43
    buffer_store_dwordx2 v[52:53], v6, s[28:31], 0 offen offset:32
    v_cvt_pk_bf16_f32 v54, v44, v45
    v_cvt_pk_bf16_f32 v55, v46, v47
    buffer_store_dwordx2 v[54:55], v6, s[28:31], 0 offen offset:48
L_k3_end:
    s_endpgm
.section .rodata,"a"
.p2align 6
.amdhsa_kernel outproj_kernel
    .amdhsa_next_free_vgpr 256
    .amdhsa_next_free_sgpr 102
    .amdhsa_accum_offset 256
    .amdhsa_group_segment_fixed_size 0
    .amdhsa_kernarg_size 88
    .amdhsa_user_sgpr_count 2
    .amdhsa_user_sgpr_kernarg_segment_ptr 1
    .amdhsa_system_sgpr_workgroup_id_x 1
.end_amdhsa_kernel
.text
```
